```python
import torch

def _softmax(x, axis=-1):
    return torch.softmax(x, dim=axis)
def _gelu(x):
    return torch.nn.functional.gelu(x, approximate="tanh")
def _silu(x):
    return torch.nn.functional.silu(x)
def _sigmoid(x):
    return torch.sigmoid(x)
def _layernorm(x, axis=-1, eps=1e-5):
    m = x.mean(dim=axis, keepdim=True)
    v = x.var(dim=axis, keepdim=True, unbiased=False)
    return (x - m) / torch.sqrt(v + eps)
def _scatter_add(tgt, idx, src, axis=0):
    return tgt.clone().index_add_(axis, idx, src)
def _segment_sum(src, seg, n):
    out = torch.zeros((n,) + src.shape[1:], dtype=src.dtype)
    return out.index_add_(0, seg, src)
def _pad(x, pw):
    flat = tuple(v for pair in reversed(pw) for v in pair)
    return torch.nn.functional.pad(x, flat)

kernel_name = 'standalone__fft_conv__vision'

def setup_inputs():

    _w = (lambda a: (lambda t: t.to(torch.bfloat16) if t.is_floating_point() else t)(torch.as_tensor(a)))
    H = W = 224
    C = 96
    K = 3
    return {
        "x": _w((lambda *s: torch.randn(*s, dtype=torch.bfloat16) * 0.05)(1, H, W, C)),
        "w": _w((lambda *s: torch.randn(*s, dtype=torch.bfloat16) * 0.05)(K, K, C, C)),
    }

def reference(x, w):
    B, H, W, C = x.shape
    K = w.shape[0]
    wp = _pad(w, ((0, H - K), (0, W - K), (0, 0), (0, 0)))
    Xf = (lambda x, axes=(-2,-1): torch.fft.rfft2(x.float(), dim=axes))(x, axes=(1, 2))
    Wf = (lambda x, axes=(-2,-1): torch.fft.rfft2(x.float(), dim=axes))(wp, axes=(0, 1))
    Yf = torch.einsum('bhwi,hwio->bhwo', Xf, Wf)
    y = (lambda x, s, axes=(-2,-1): torch.fft.irfft2(x, s=s, dim=axes).to(torch.bfloat16))(Yf, (H, W), axes=(1, 2))
    return y
```

```asm
; @launch grid=(224,1,1) block=(256,1,1) lds=148096
.amdgcn_target "amdgcn-amd-amdhsa--gfx950"
.text
.globl standalone__fft_conv__vision_kernel
.p2align 12
.type standalone__fft_conv__vision_kernel,@function
standalone__fft_conv__vision_kernel:
    s_load_dwordx4 s[4:7], s[0:1], 0
    s_load_dwordx2 s[12:13], s[0:1], 16
    s_cmp_ge_u32 s2, 224
    s_cbranch_scc1 L_end
    v_lshrrev_b32 v16, 6, v0
    v_and_b32 v0, 63, v0
    v_readfirstlane_b32 s32, v16
    s_and_b32 s36, s2, 7
    s_mul_i32 s36, s36, 28
    s_lshr_b32 s37, s2, 3
    s_add_u32 s36, s36, s37
    s_mul_i32 s37, s36, 4682
    s_lshr_b32 s37, s37, 16
    s_mul_i32 s38, s37, 14
    s_sub_u32 s36, s36, s38
    s_lshl_b32 s36, s36, 4
    s_mul_i32 s33, s32, 1536
    v_lshlrev_b32 v8, 4, v0
    v_add_u32 v8, s33, v8
    v_lshrrev_b32 v16, 5, v0
    v_mul_u32_u24 v16, 53760, v16
    v_add_u32 v9, v8, v16
    v_add_u32 v10, 53760, v8
    v_add_u32 v11, 107520, v8
    v_add_u32 v12, 111616, v8
    s_mul_i32 s34, s32, 4640
    s_add_u32 s34, s34, 55296
    s_lshl_b32 s33, s32, 6
    v_add_u32 v16, s33, v0
    v_mul_u32_u24 v17, 171, v16
    v_lshrrev_b32 v17, 11, v17
    v_mul_u32_u24 v18, 12, v17
    v_sub_u32 v16, v16, v18
    v_lshrrev_b32 v18, 1, v17
    v_and_b32 v18, 2, v18
    v_xor_b32 v16, v16, v18
    v_add_u32 v17, s36, v17
    v_subrev_u32 v17, 2, v17
    v_add_u32 v18, 224, v17
    v_min_u32 v17, v17, v18
    v_mul_u32_u24 v17, 192, v17
    v_lshl_add_u32 v13, v16, 4, v17
    s_lshl_b32 s33, s32, 10
    s_mul_i32 s18, s38, 43008
    s_add_u32 s25, s18, 301056
    s_lshr_b32 s39, s2, 3
    s_mul_i32 s3, s39, 21846
    s_lshr_b32 s3, s3, 16
    s_mul_i32 s93, s3, 3
    s_sub_u32 s93, s39, s93
    s_mul_i32 s94, s3, 21846
    s_lshr_b32 s94, s94, 16
    s_mul_i32 s94, s94, 3
    s_sub_u32 s94, s3, s94
    s_mul_i32 s76, s93, 18432
    s_mul_i32 s80, s94, 6144
    s_add_u32 s84, s76, s80
    s_cmp_eq_u32 s32, 3
    s_cselect_b32 s98, 0xffffff, -1
    s_cselect_b32 s99, 0, -1
    s_waitcnt lgkmcnt(0)
    s_mov_b32 s8, s6
    s_mov_b32 s9, s7
    s_mov_b32 s10, 165888
    s_mov_b32 s11, 0x20000
    s_mov_b32 s6, 9633792
    s_mov_b32 s7, 0x20000
    s_mov_b32 s14, 9633792
    s_mov_b32 s15, 0x20000
    s_add_u32 m0, s33, 6912
    s_mov_b64 exec, s[98:99]
    buffer_load_dwordx4 v13, s[4:7], s18 offen lds
    s_mov_b64 exec, -1
    s_add_u32 m0, s33, 31104
    s_mov_b64 exec, s[98:99]
    buffer_load_dwordx4 v13, s[4:7], s25 offen lds
    s_mov_b64 exec, -1
    s_add_u32 m0, s34, 0
    s_nop 0
    buffer_load_dwordx4 v8, s[8:11], s84 offen lds
    buffer_load_dwordx4 v9, s[8:11], s84 offen offset:1024 lds
    buffer_load_dwordx4 v10, s[8:11], s84 offen offset:2048 lds
    buffer_load_dwordx4 v11, s[8:11], s84 offen offset:3072 lds
    s_add_u32 m0, s34, 4096
    s_mov_b32 exec_hi, 0
    buffer_load_dwordx4 v12, s[8:11], s84 offen lds
    s_mov_b32 exec_hi, -1
    s_mov_b64 vcc, -1
    v_mov_b32 v14, 0
    v_mov_b32 v15, 0
    s_cmp_eq_u32 s32, 3
    s_cbranch_scc1 L_pad0
    s_cmp_eq_u32 s32, 2
    s_cbranch_scc1 L_pad1
L_main:
    s_mov_b64 vcc, 0
    s_add_u32 s77, s76, 18432
    s_cmp_eq_u32 s77, 55296
    s_cselect_b32 s77, 0, s77
    s_add_u32 s81, s80, 6144
    s_cmp_eq_u32 s81, 18432
    s_cselect_b32 s81, 0, s81
    s_add_u32 s78, s77, 18432
    s_cmp_eq_u32 s78, 55296
    s_cselect_b32 s78, 0, s78
    s_add_u32 s82, s81, 6144
    s_cmp_eq_u32 s82, 18432
    s_cselect_b32 s82, 0, s82
    s_add_u32 s85, s76, s81
    s_add_u32 s86, s76, s82
    s_add_u32 s87, s77, s80
    s_add_u32 s88, s77, s81
    s_add_u32 s89, s77, s82
    s_add_u32 s90, s78, s80
    s_add_u32 s91, s78, s81
    s_add_u32 s92, s78, s82
    s_add_u32 s39, s38, 222
    s_sub_u32 s16, s38, 2
    s_cmp_eq_u32 s38, 0
    s_cselect_b32 s16, s39, s16
    s_mul_i32 s16, s16, 43008
    s_add_u32 s17, s16, 43008
    s_add_u32 s19, s18, 43008
    s_add_u32 s20, s18, 86016
    s_add_u32 s21, s18, 129024
    s_add_u32 s22, s18, 172032
    s_add_u32 s23, s18, 215040
    s_add_u32 s24, s18, 258048
    s_add_u32 s26, s18, 344064
    s_add_u32 s27, s18, 387072
    s_add_u32 s28, s18, 430080
    s_add_u32 s29, s18, 473088
    s_add_u32 s30, s18, 516096
    s_add_u32 s31, s18, 559104
    s_add_u32 m0, s33, 10368
    s_mov_b64 exec, s[98:99]
    buffer_load_dwordx4 v13, s[4:7], s19 offen lds
    s_mov_b64 exec, -1
    s_add_u32 m0, s33, 34560
    s_mov_b64 exec, s[98:99]
    buffer_load_dwordx4 v13, s[4:7], s26 offen lds
    s_mov_b64 exec, -1
    s_add_u32 m0, s34, 18560
    s_nop 0
    buffer_load_dwordx4 v8, s[8:11], s85 offen lds
    buffer_load_dwordx4 v9, s[8:11], s85 offen offset:1024 lds
    buffer_load_dwordx4 v10, s[8:11], s85 offen offset:2048 lds
    buffer_load_dwordx4 v11, s[8:11], s85 offen offset:3072 lds
    s_add_u32 m0, s34, 22656
    s_mov_b32 exec_hi, 0
    buffer_load_dwordx4 v12, s[8:11], s85 offen lds
    s_mov_b32 exec_hi, -1
    s_add_u32 m0, s33, 3456
    s_mov_b64 exec, s[98:99]
    buffer_load_dwordx4 v13, s[4:7], s17 offen lds
    s_mov_b64 exec, -1
    s_add_u32 m0, s33, 27648
    s_mov_b64 exec, s[98:99]
    buffer_load_dwordx4 v13, s[4:7], s24 offen lds
    s_mov_b64 exec, -1
    v_lshrrev_b32 v16, 4, v0
    v_and_b32 v17, 15, v0
    s_and_b32 s39, s32, 1
    s_lshr_b32 s3, s32, 1
    v_mul_u32_u24 v1, 4640, v16
    v_bfe_u32 v18, v0, 2, 2
    v_mul_u32_u24 v18, 192, v18
    v_add_u32 v1, v1, v18
    v_and_b32 v18, 3, v0
    v_lshl_add_u32 v1, v18, 3, v1
    v_add_u32 v1, 55296, v1
    s_lshl_b32 s35, s39, 5
    s_add_u32 s35, s35, 64
    v_add_u32 v2, s35, v1
    s_lshl_b32 s39, s39, 7
    v_add_u32 v1, s39, v1
    v_add_u32 v3, 55680, v1
    v_add_u32 v4, 55680, v2
    v_mul_u32_u24 v14, 192, v17
    v_lshl_add_u32 v15, v16, 3, v14
    v_add_u32 v15, s35, v15
    v_and_b32 v18, 1, v16
    v_lshl_add_u32 v14, v18, 5, v14
    v_lshrrev_b32 v18, 1, v16
    v_lshl_add_u32 v14, v18, 4, v14
    v_add_u32 v14, s39, v14
    s_mul_i32 s39, s3, 24192
    s_sub_u32 s93, 2, s93
    v_add_u32 v18, s93, v17
    s_sub_u32 s93, s93, 1
    s_cselect_b32 s93, 2, s93
    v_lshrrev_b32 v19, 1, v18
    v_and_b32 v19, 2, v19
    v_xor_b32 v19, v19, v16
    v_mul_u32_u24 v18, 192, v18
    v_lshl_add_u32 v5, v19, 4, v18
    v_add_u32 v18, s93, v17
    s_sub_u32 s93, s93, 1
    s_cselect_b32 s93, 2, s93
    v_lshrrev_b32 v19, 1, v18
    v_and_b32 v19, 2, v19
    v_xor_b32 v19, v19, v16
    v_mul_u32_u24 v18, 192, v18
    v_lshl_add_u32 v6, v19, 4, v18
    v_add_u32 v18, s93, v17
    v_lshrrev_b32 v19, 1, v18
    v_and_b32 v19, 2, v19
    v_xor_b32 v19, v19, v16
    v_mul_u32_u24 v18, 192, v18
    v_lshl_add_u32 v7, v19, 4, v18
    s_lshr_b32 s80, s80, 11
    s_mul_i32 s80, s80, 21
    s_add_u32 s80, s80, 63
    s_and_b32 s80, s80, 0xc0
    s_add_u32 s80, s80, s39
    s_lshr_b32 s81, s81, 11
    s_mul_i32 s81, s81, 21
    s_add_u32 s81, s81, 63
    s_and_b32 s81, s81, 0xc0
    s_add_u32 s81, s81, s39
    s_lshr_b32 s82, s82, 11
    s_mul_i32 s82, s82, 21
    s_add_u32 s82, s82, 63
    s_and_b32 s82, s82, 0xc0
    s_add_u32 s82, s82, s39
    v_add_u32 v200, s80, v5
    v_add_u32 v201, s81, v5
    v_add_u32 v202, s82, v5
    v_add_u32 v203, s80, v6
    v_add_u32 v204, s81, v6
    v_add_u32 v205, s82, v6
    v_add_u32 v206, s80, v7
    v_add_u32 v207, s81, v7
    v_add_u32 v208, s82, v7
    s_mul_i32 s3, s3, 7
    s_add_u32 s3, s3, s38
    s_mul_i32 s3, s3, 224
    s_add_u32 s3, s3, s36
    s_mul_i32 s35, s3, 192
    s_add_u32 m0, s34, 37120
    s_nop 0
    buffer_load_dwordx4 v8, s[8:11], s86 offen lds
    buffer_load_dwordx4 v9, s[8:11], s86 offen offset:1024 lds
    buffer_load_dwordx4 v10, s[8:11], s86 offen offset:2048 lds
    buffer_load_dwordx4 v11, s[8:11], s86 offen offset:3072 lds
    s_add_u32 m0, s34, 41216
    s_mov_b32 exec_hi, 0
    buffer_load_dwordx4 v12, s[8:11], s86 offen lds
    s_mov_b32 exec_hi, -1
    s_add_u32 m0, s33, 0
    s_mov_b64 exec, s[98:99]
    buffer_load_dwordx4 v13, s[4:7], s16 offen lds
    s_mov_b64 exec, -1
    s_add_u32 m0, s33, 24192
    s_mov_b64 exec, s[98:99]
    buffer_load_dwordx4 v13, s[4:7], s23 offen lds
    s_mov_b64 exec, -1
    s_waitcnt vmcnt(16)
    s_barrier
    ds_read_b128 v[32:35], v200 offset:6912
    ds_read_b64_tr_b16 a[24:25], v1 offset:3072
    ds_read_b64_tr_b16 a[26:27], v1 offset:3840
    ds_read_b64_tr_b16 a[28:29], v1 offset:3104
    ds_read_b64_tr_b16 a[30:31], v1 offset:3872
    ds_read_b64_tr_b16 a[32:33], v2 offset:3072
    ds_read_b64_tr_b16 a[34:35], v2 offset:3840
    ds_read_b64_tr_b16 a[12:13], v1 offset:1536
    ds_read_b64_tr_b16 a[14:15], v1 offset:2304
    ds_read_b64_tr_b16 a[16:17], v1 offset:1568
    ds_read_b64_tr_b16 a[18:19], v1 offset:2336
    ds_read_b64_tr_b16 a[20:21], v2 offset:1536
    ds_read_b64_tr_b16 a[22:23], v2 offset:2304
    ds_read_b64_tr_b16 a[0:1], v1 offset:0
    ds_read_b64_tr_b16 a[2:3], v1 offset:768
    ds_read_b64_tr_b16 a[4:5], v1 offset:32
    ds_read_b64_tr_b16 a[6:7], v1 offset:800
    ds_read_b64_tr_b16 a[8:9], v2 offset:0
    ds_read_b64_tr_b16 a[10:11], v2 offset:768
    s_add_u32 m0, s34, 55680
    s_nop 0
    buffer_load_dwordx4 v8, s[8:11], s87 offen lds
    buffer_load_dwordx4 v9, s[8:11], s87 offen offset:1024 lds
    s_waitcnt lgkmcnt(15)
    v_mfma_f32_16x16x32_bf16 v[72:75], a[24:27], v[32:35], 0
    s_waitcnt lgkmcnt(14)
    v_mfma_f32_16x16x32_bf16 v[76:79], a[28:31], v[32:35], 0
    buffer_load_dwordx4 v10, s[8:11], s87 offen offset:2048 lds
    s_waitcnt lgkmcnt(12)
    v_mfma_f32_16x16x32_bf16 v[80:83], a[32:35], v[32:35], 0
    s_waitcnt lgkmcnt(10)
    v_mfma_f32_16x16x32_bf16 v[60:63], a[12:15], v[32:35], 0
    buffer_load_dwordx4 v11, s[8:11], s87 offen offset:3072 lds
    s_waitcnt lgkmcnt(8)
    v_mfma_f32_16x16x32_bf16 v[64:67], a[16:19], v[32:35], 0
    s_waitcnt lgkmcnt(6)
    v_mfma_f32_16x16x32_bf16 v[68:71], a[20:23], v[32:35], 0
    s_add_u32 m0, s34, 59776
    s_mov_b32 exec_hi, 0
    buffer_load_dwordx4 v12, s[8:11], s87 offen lds
    s_mov_b32 exec_hi, -1
    s_waitcnt lgkmcnt(4)
    v_mfma_f32_16x16x32_bf16 v[48:51], a[0:3], v[32:35], 0
    s_waitcnt lgkmcnt(2)
    v_mfma_f32_16x16x32_bf16 v[52:55], a[4:7], v[32:35], 0
    s_add_u32 m0, s34, 74240
    s_nop 0
    buffer_load_dwordx4 v8, s[8:11], s88 offen lds
    s_waitcnt lgkmcnt(0)
    v_mfma_f32_16x16x32_bf16 v[56:59], a[8:11], v[32:35], 0
    buffer_load_dwordx4 v9, s[8:11], s88 offen offset:1024 lds
    buffer_load_dwordx4 v10, s[8:11], s88 offen offset:2048 lds
    buffer_load_dwordx4 v11, s[8:11], s88 offen offset:3072 lds
    s_add_u32 m0, s34, 78336
    s_mov_b32 exec_hi, 0
    buffer_load_dwordx4 v12, s[8:11], s88 offen lds
    s_mov_b32 exec_hi, -1
    s_waitcnt vmcnt(19)
    s_barrier
    ds_read_b128 v[36:39], v200 offset:10368
    ds_read_b128 v[40:43], v201 offset:6912
    ds_read_b128 v[44:47], v201 offset:10368
    s_waitcnt lgkmcnt(2)
    v_mfma_f32_16x16x32_bf16 v[84:87], a[24:27], v[36:39], 0
    ds_read_b64_tr_b16 a[60:61], v1 offset:21632
    ds_read_b64_tr_b16 a[62:63], v1 offset:22400
    v_mfma_f32_16x16x32_bf16 v[88:91], a[28:31], v[36:39], 0
    ds_read_b64_tr_b16 a[64:65], v1 offset:21664
    ds_read_b64_tr_b16 a[66:67], v1 offset:22432
    v_mfma_f32_16x16x32_bf16 v[92:95], a[32:35], v[36:39], 0
    ds_read_b64_tr_b16 a[68:69], v2 offset:21632
    ds_read_b64_tr_b16 a[70:71], v2 offset:22400
    v_mfma_f32_16x16x32_bf16 v[72:75], a[12:15], v[36:39], v[72:75]
    s_add_u32 m0, s34, 0
    s_nop 0
    buffer_load_dwordx4 v8, s[8:11], s89 offen lds
    v_mfma_f32_16x16x32_bf16 v[76:79], a[16:19], v[36:39], v[76:79]
    ds_read_b64_tr_b16 a[48:49], v1 offset:20096
    ds_read_b64_tr_b16 a[50:51], v1 offset:20864
    v_mfma_f32_16x16x32_bf16 v[80:83], a[20:23], v[36:39], v[80:83]
    ds_read_b64_tr_b16 a[52:53], v1 offset:20128
    ds_read_b64_tr_b16 a[54:55], v1 offset:20896
    v_mfma_f32_16x16x32_bf16 v[60:63], a[0:3], v[36:39], v[60:63]
    ds_read_b64_tr_b16 a[56:57], v2 offset:20096
    ds_read_b64_tr_b16 a[58:59], v2 offset:20864
    v_mfma_f32_16x16x32_bf16 v[64:67], a[4:7], v[36:39], v[64:67]
    buffer_load_dwordx4 v9, s[8:11], s89 offen offset:1024 lds
    v_mfma_f32_16x16x32_bf16 v[68:71], a[8:11], v[36:39], v[68:71]
    ds_read_b64_tr_b16 a[36:37], v1 offset:18560
    ds_read_b64_tr_b16 a[38:39], v1 offset:19328
    s_waitcnt lgkmcnt(12)
    v_mfma_f32_16x16x32_bf16 v[72:75], a[60:63], v[40:43], v[72:75]
    ds_read_b64_tr_b16 a[40:41], v1 offset:18592
    ds_read_b64_tr_b16 a[42:43], v1 offset:19360
    s_waitcnt lgkmcnt(12)
    v_mfma_f32_16x16x32_bf16 v[76:79], a[64:67], v[40:43], v[76:79]
    ds_read_b64_tr_b16 a[44:45], v2 offset:18560
    ds_read_b64_tr_b16 a[46:47], v2 offset:19328
    s_waitcnt lgkmcnt(12)
    v_mfma_f32_16x16x32_bf16 v[80:83], a[68:71], v[40:43], v[80:83]
    buffer_load_dwordx4 v10, s[8:11], s89 offen offset:2048 lds
    s_waitcnt lgkmcnt(10)
    v_mfma_f32_16x16x32_bf16 v[60:63], a[48:51], v[40:43], v[60:63]
    s_waitcnt lgkmcnt(8)
    v_mfma_f32_16x16x32_bf16 v[64:67], a[52:55], v[40:43], v[64:67]
    s_waitcnt lgkmcnt(6)
    v_mfma_f32_16x16x32_bf16 v[68:71], a[56:59], v[40:43], v[68:71]
    s_waitcnt lgkmcnt(4)
    v_mfma_f32_16x16x32_bf16 v[48:51], a[36:39], v[40:43], v[48:51]
    buffer_load_dwordx4 v11, s[8:11], s89 offen offset:3072 lds
    s_waitcnt lgkmcnt(2)
    v_mfma_f32_16x16x32_bf16 v[52:55], a[40:43], v[40:43], v[52:55]
    s_waitcnt lgkmcnt(0)
    v_mfma_f32_16x16x32_bf16 v[56:59], a[44:47], v[40:43], v[56:59]
    v_mfma_f32_16x16x32_bf16 v[84:87], a[60:63], v[44:47], v[84:87]
    v_mfma_f32_16x16x32_bf16 v[88:91], a[64:67], v[44:47], v[88:91]
    s_add_u32 m0, s34, 4096
    s_mov_b32 exec_hi, 0
    buffer_load_dwordx4 v12, s[8:11], s89 offen lds
    s_mov_b32 exec_hi, -1
    v_mfma_f32_16x16x32_bf16 v[92:95], a[68:71], v[44:47], v[92:95]
    v_mfma_f32_16x16x32_bf16 v[72:75], a[48:51], v[44:47], v[72:75]
    v_mfma_f32_16x16x32_bf16 v[76:79], a[52:55], v[44:47], v[76:79]
    v_mfma_f32_16x16x32_bf16 v[80:83], a[56:59], v[44:47], v[80:83]
    v_mfma_f32_16x16x32_bf16 v[60:63], a[36:39], v[44:47], v[60:63]
    v_mfma_f32_16x16x32_bf16 v[64:67], a[40:43], v[44:47], v[64:67]
    v_mfma_f32_16x16x32_bf16 v[68:71], a[44:47], v[44:47], v[68:71]
    s_waitcnt vmcnt(10)
    s_barrier
    ds_read_b128 v[32:35], v200 offset:3456
    ds_read_b128 v[36:39], v201 offset:3456
    ds_read_b128 v[40:43], v200 offset:0
    s_waitcnt lgkmcnt(2)
    v_mfma_f32_16x16x32_bf16 v[60:63], a[24:27], v[32:35], v[60:63]
    s_add_u32 m0, s34, 18560
    s_nop 0
    buffer_load_dwordx4 v8, s[8:11], s90 offen lds
    v_mfma_f32_16x16x32_bf16 v[64:67], a[28:31], v[32:35], v[64:67]
    ds_read_b64_tr_b16 a[96:97], v1 offset:40192
    ds_read_b64_tr_b16 a[98:99], v1 offset:40960
    v_mfma_f32_16x16x32_bf16 v[68:71], a[32:35], v[32:35], v[68:71]
    ds_read_b64_tr_b16 a[100:101], v1 offset:40224
    ds_read_b64_tr_b16 a[102:103], v1 offset:40992
    v_mfma_f32_16x16x32_bf16 v[48:51], a[12:15], v[32:35], v[48:51]
    ds_read_b64_tr_b16 a[104:105], v2 offset:40192
    ds_read_b64_tr_b16 a[106:107], v2 offset:40960
    v_mfma_f32_16x16x32_bf16 v[52:55], a[16:19], v[32:35], v[52:55]
    buffer_load_dwordx4 v9, s[8:11], s90 offen offset:1024 lds
    v_mfma_f32_16x16x32_bf16 v[56:59], a[20:23], v[32:35], v[56:59]
    ds_read_b64_tr_b16 a[84:85], v1 offset:38656
    ds_read_b64_tr_b16 a[86:87], v1 offset:39424
    ds_read_b128 v[44:47], v201 offset:0
    s_waitcnt lgkmcnt(10)
    v_mfma_f32_16x16x32_bf16 v[60:63], a[60:63], v[36:39], v[60:63]
    ds_read_b64_tr_b16 a[88:89], v1 offset:38688
    v_mfma_f32_16x16x32_bf16 v[64:67], a[64:67], v[36:39], v[64:67]
    ds_read_b64_tr_b16 a[90:91], v1 offset:39456
    v_mfma_f32_16x16x32_bf16 v[68:71], a[68:71], v[36:39], v[68:71]
    buffer_load_dwordx4 v10, s[8:11], s90 offen offset:2048 lds
    v_mfma_f32_16x16x32_bf16 v[48:51], a[48:51], v[36:39], v[48:51]
    ds_read_b64_tr_b16 a[92:93], v2 offset:38656
    v_mfma_f32_16x16x32_bf16 v[52:55], a[52:55], v[36:39], v[52:55]
    ds_read_b64_tr_b16 a[94:95], v2 offset:39424
    v_mfma_f32_16x16x32_bf16 v[56:59], a[56:59], v[36:39], v[56:59]
    ds_read_b64_tr_b16 a[72:73], v1 offset:37120
    ds_read_b128 v[32:35], v202 offset:6912
    s_waitcnt lgkmcnt(15)
    v_mfma_f32_16x16x32_bf16 v[48:51], a[24:27], v[40:43], v[48:51]
    buffer_load_dwordx4 v11, s[8:11], s90 offen offset:3072 lds
    v_mfma_f32_16x16x32_bf16 v[52:55], a[28:31], v[40:43], v[52:55]
    ds_read_b64_tr_b16 a[74:75], v1 offset:37888
    v_mfma_f32_16x16x32_bf16 v[56:59], a[32:35], v[40:43], v[56:59]
    ds_read_b64_tr_b16 a[76:77], v1 offset:37152
    ds_read_b128 v[36:39], v202 offset:10368
    s_waitcnt lgkmcnt(9)
    v_mfma_f32_16x16x32_bf16 v[48:51], a[60:63], v[44:47], v[48:51]
    ds_read_b64_tr_b16 a[78:79], v1 offset:37920
    v_mfma_f32_16x16x32_bf16 v[52:55], a[64:67], v[44:47], v[52:55]
    s_add_u32 m0, s34, 22656
    s_mov_b32 exec_hi, 0
    buffer_load_dwordx4 v12, s[8:11], s90 offen lds
    s_mov_b32 exec_hi, -1
    v_mfma_f32_16x16x32_bf16 v[56:59], a[68:71], v[44:47], v[56:59]
    ds_read_b64_tr_b16 a[80:81], v2 offset:37120
    ds_read_b128 v[40:43], v202 offset:3456
    s_waitcnt lgkmcnt(6)
    v_mfma_f32_16x16x32_bf16 v[72:75], a[96:99], v[32:35], v[72:75]
    ds_read_b64_tr_b16 a[82:83], v2 offset:37888
    v_mfma_f32_16x16x32_bf16 v[76:79], a[100:103], v[32:35], v[76:79]
    ds_read_b64_tr_b16 a[132:133], v3 offset:3072
    v_mfma_f32_16x16x32_bf16 v[80:83], a[104:107], v[32:35], v[80:83]
    ds_read_b64_tr_b16 a[134:135], v3 offset:3840
    v_mfma_f32_16x16x32_bf16 v[60:63], a[84:87], v[32:35], v[60:63]
    ds_read_b64_tr_b16 a[136:137], v3 offset:3104
    v_mfma_f32_16x16x32_bf16 v[64:67], a[88:91], v[32:35], v[64:67]
    ds_read_b64_tr_b16 a[138:139], v3 offset:3872
    v_mfma_f32_16x16x32_bf16 v[68:71], a[92:95], v[32:35], v[68:71]
    ds_read_b64_tr_b16 a[140:141], v4 offset:3072
    s_waitcnt lgkmcnt(11)
    v_mfma_f32_16x16x32_bf16 v[48:51], a[72:75], v[32:35], v[48:51]
    ds_read_b64_tr_b16 a[142:143], v4 offset:3840
    s_waitcnt lgkmcnt(9)
    v_mfma_f32_16x16x32_bf16 v[52:55], a[76:79], v[32:35], v[52:55]
    ds_read_b64_tr_b16 a[120:121], v3 offset:1536
    s_waitcnt lgkmcnt(7)
    v_mfma_f32_16x16x32_bf16 v[56:59], a[80:83], v[32:35], v[56:59]
    ds_read_b64_tr_b16 a[122:123], v3 offset:2304
    ds_read_b128 v[44:47], v202 offset:0
    v_mfma_f32_16x16x32_bf16 v[84:87], a[96:99], v[36:39], v[84:87]
    ds_read_b64_tr_b16 a[124:125], v3 offset:1568
    v_mfma_f32_16x16x32_bf16 v[88:91], a[100:103], v[36:39], v[88:91]
    ds_read_b64_tr_b16 a[126:127], v3 offset:2336
    v_mfma_f32_16x16x32_bf16 v[92:95], a[104:107], v[36:39], v[92:95]
    ds_read_b64_tr_b16 a[128:129], v4 offset:1536
    v_mfma_f32_16x16x32_bf16 v[72:75], a[84:87], v[36:39], v[72:75]
    ds_read_b64_tr_b16 a[130:131], v4 offset:2304
    v_mfma_f32_16x16x32_bf16 v[76:79], a[88:91], v[36:39], v[76:79]
    ds_read_b64_tr_b16 a[108:109], v3 offset:0
    v_mfma_f32_16x16x32_bf16 v[80:83], a[92:95], v[36:39], v[80:83]
    ds_read_b64_tr_b16 a[110:111], v3 offset:768
    v_mfma_f32_16x16x32_bf16 v[60:63], a[72:75], v[36:39], v[60:63]
    ds_read_b64_tr_b16 a[112:113], v3 offset:32
    v_mfma_f32_16x16x32_bf16 v[64:67], a[76:79], v[36:39], v[64:67]
    ds_read_b64_tr_b16 a[114:115], v3 offset:800
    v_mfma_f32_16x16x32_bf16 v[68:71], a[80:83], v[36:39], v[68:71]
    ds_read_b64_tr_b16 a[116:117], v4 offset:0
    ds_read_b128 v[32:35], v203 offset:6912
    v_mfma_f32_16x16x32_bf16 v[60:63], a[96:99], v[40:43], v[60:63]
    ds_read_b64_tr_b16 a[118:119], v4 offset:768
    v_mfma_f32_16x16x32_bf16 v[64:67], a[100:103], v[40:43], v[64:67]
    v_mfma_f32_16x16x32_bf16 v[68:71], a[104:107], v[40:43], v[68:71]
    v_mfma_f32_16x16x32_bf16 v[48:51], a[84:87], v[40:43], v[48:51]
    v_mfma_f32_16x16x32_bf16 v[52:55], a[88:91], v[40:43], v[52:55]
    v_mfma_f32_16x16x32_bf16 v[56:59], a[92:95], v[40:43], v[56:59]
    ds_read_b128 v[36:39], v203 offset:10368
    s_waitcnt lgkmcnt(12)
    v_mfma_f32_16x16x32_bf16 v[48:51], a[96:99], v[44:47], v[48:51]
    v_mfma_f32_16x16x32_bf16 v[52:55], a[100:103], v[44:47], v[52:55]
    v_mfma_f32_16x16x32_bf16 v[56:59], a[104:107], v[44:47], v[56:59]
    ds_read_b128 v[40:43], v203 offset:3456
    s_waitcnt lgkmcnt(2)
    s_waitcnt vmcnt(5)
    s_barrier
    v_mfma_f32_16x16x32_bf16 v[72:75], a[132:135], v[32:35], v[72:75]
    s_add_u32 m0, s34, 37120
    s_nop 0
    buffer_load_dwordx4 v8, s[8:11], s91 offen lds
    v_mfma_f32_16x16x32_bf16 v[76:79], a[136:139], v[32:35], v[76:79]
    ds_read_b64_tr_b16 a[168:169], v3 offset:21632
    v_mfma_f32_16x16x32_bf16 v[80:83], a[140:143], v[32:35], v[80:83]
    ds_read_b64_tr_b16 a[170:171], v3 offset:22400
    v_mfma_f32_16x16x32_bf16 v[60:63], a[120:123], v[32:35], v[60:63]
    ds_read_b64_tr_b16 a[172:173], v3 offset:21664
    v_mfma_f32_16x16x32_bf16 v[64:67], a[124:127], v[32:35], v[64:67]
    buffer_load_dwordx4 v9, s[8:11], s91 offen offset:1024 lds
    v_mfma_f32_16x16x32_bf16 v[68:71], a[128:131], v[32:35], v[68:71]
    ds_read_b64_tr_b16 a[174:175], v3 offset:22432
L_pad0:
    s_cbranch_vccnz L_main
    v_mfma_f32_16x16x32_bf16 v[48:51], a[108:111], v[32:35], v[48:51]
    ds_read_b64_tr_b16 a[176:177], v4 offset:21632
    v_mfma_f32_16x16x32_bf16 v[52:55], a[112:115], v[32:35], v[52:55]
    ds_read_b64_tr_b16 a[178:179], v4 offset:22400
    v_mfma_f32_16x16x32_bf16 v[56:59], a[116:119], v[32:35], v[56:59]
    buffer_load_dwordx4 v10, s[8:11], s91 offen offset:2048 lds
    ds_read_b128 v[44:47], v203 offset:0
    s_waitcnt lgkmcnt(8)
    v_mfma_f32_16x16x32_bf16 v[84:87], a[132:135], v[36:39], v[84:87]
    ds_read_b64_tr_b16 a[156:157], v3 offset:20096
    v_mfma_f32_16x16x32_bf16 v[88:91], a[136:139], v[36:39], v[88:91]
    ds_read_b64_tr_b16 a[158:159], v3 offset:20864
    v_mfma_f32_16x16x32_bf16 v[92:95], a[140:143], v[36:39], v[92:95]
    ds_read_b64_tr_b16 a[160:161], v3 offset:20128
    v_mfma_f32_16x16x32_bf16 v[72:75], a[120:123], v[36:39], v[72:75]
    buffer_load_dwordx4 v11, s[8:11], s91 offen offset:3072 lds
    v_mfma_f32_16x16x32_bf16 v[76:79], a[124:127], v[36:39], v[76:79]
    ds_read_b64_tr_b16 a[162:163], v3 offset:20896
    v_mfma_f32_16x16x32_bf16 v[80:83], a[128:131], v[36:39], v[80:83]
    ds_read_b64_tr_b16 a[164:165], v4 offset:20096
    v_mfma_f32_16x16x32_bf16 v[60:63], a[108:111], v[36:39], v[60:63]
    ds_read_b64_tr_b16 a[166:167], v4 offset:20864
    v_mfma_f32_16x16x32_bf16 v[64:67], a[112:115], v[36:39], v[64:67]
    s_add_u32 m0, s34, 41216
    s_mov_b32 exec_hi, 0
    buffer_load_dwordx4 v12, s[8:11], s91 offen lds
    s_mov_b32 exec_hi, -1
    v_mfma_f32_16x16x32_bf16 v[68:71], a[116:119], v[36:39], v[68:71]
    ds_read_b64_tr_b16 a[144:145], v3 offset:18560
    ds_read_b128 v[32:35], v204 offset:6912
    s_waitcnt lgkmcnt(15)
    v_mfma_f32_16x16x32_bf16 v[60:63], a[132:135], v[40:43], v[60:63]
    ds_read_b64_tr_b16 a[146:147], v3 offset:19328
    v_mfma_f32_16x16x32_bf16 v[64:67], a[136:139], v[40:43], v[64:67]
    ds_read_b64_tr_b16 a[148:149], v3 offset:18592
    v_mfma_f32_16x16x32_bf16 v[68:71], a[140:143], v[40:43], v[68:71]
    s_add_u32 m0, s34, 55680
    s_nop 0
    buffer_load_dwordx4 v8, s[8:11], s92 offen lds
    v_mfma_f32_16x16x32_bf16 v[48:51], a[120:123], v[40:43], v[48:51]
    ds_read_b64_tr_b16 a[150:151], v3 offset:19360
    v_mfma_f32_16x16x32_bf16 v[52:55], a[124:127], v[40:43], v[52:55]
    ds_read_b64_tr_b16 a[152:153], v4 offset:18560
    v_mfma_f32_16x16x32_bf16 v[56:59], a[128:131], v[40:43], v[56:59]
    ds_read_b64_tr_b16 a[154:155], v4 offset:19328
    ds_read_b128 v[36:39], v204 offset:10368
    s_waitcnt lgkmcnt(14)
    v_mfma_f32_16x16x32_bf16 v[48:51], a[132:135], v[44:47], v[48:51]
    buffer_load_dwordx4 v9, s[8:11], s92 offen offset:1024 lds
    v_mfma_f32_16x16x32_bf16 v[52:55], a[136:139], v[44:47], v[52:55]
    ds_read_b64_tr_b16 a[204:205], v1 offset:3072
    v_mfma_f32_16x16x32_bf16 v[56:59], a[140:143], v[44:47], v[56:59]
    ds_read_b64_tr_b16 a[206:207], v1 offset:3840
    ds_read_b128 v[40:43], v204 offset:3456
    s_waitcnt lgkmcnt(9)
    v_mfma_f32_16x16x32_bf16 v[72:75], a[168:171], v[32:35], v[72:75]
    ds_read_b64_tr_b16 a[208:209], v1 offset:3104
    v_mfma_f32_16x16x32_bf16 v[76:79], a[172:175], v[32:35], v[76:79]
    buffer_load_dwordx4 v10, s[8:11], s92 offen offset:2048 lds
    v_mfma_f32_16x16x32_bf16 v[80:83], a[176:179], v[32:35], v[80:83]
    ds_read_b64_tr_b16 a[210:211], v1 offset:3872
    v_mfma_f32_16x16x32_bf16 v[60:63], a[156:159], v[32:35], v[60:63]
    ds_read_b64_tr_b16 a[212:213], v2 offset:3072
    v_mfma_f32_16x16x32_bf16 v[64:67], a[160:163], v[32:35], v[64:67]
    ds_read_b64_tr_b16 a[214:215], v2 offset:3840
    v_mfma_f32_16x16x32_bf16 v[68:71], a[164:167], v[32:35], v[68:71]
    buffer_load_dwordx4 v11, s[8:11], s92 offen offset:3072 lds
    s_waitcnt lgkmcnt(12)
    v_mfma_f32_16x16x32_bf16 v[48:51], a[144:147], v[32:35], v[48:51]
    ds_read_b64_tr_b16 a[192:193], v1 offset:1536
    s_waitcnt lgkmcnt(11)
    v_mfma_f32_16x16x32_bf16 v[52:55], a[148:151], v[32:35], v[52:55]
    ds_read_b64_tr_b16 a[194:195], v1 offset:2304
    s_waitcnt lgkmcnt(10)
    v_mfma_f32_16x16x32_bf16 v[56:59], a[152:155], v[32:35], v[56:59]
    ds_read_b64_tr_b16 a[196:197], v1 offset:1568
    ds_read_b128 v[44:47], v204 offset:0
    s_waitcnt lgkmcnt(11)
    v_mfma_f32_16x16x32_bf16 v[84:87], a[168:171], v[36:39], v[84:87]
    s_add_u32 m0, s34, 59776
    s_mov_b32 exec_hi, 0
    buffer_load_dwordx4 v12, s[8:11], s92 offen lds
    s_mov_b32 exec_hi, -1
    v_mfma_f32_16x16x32_bf16 v[88:91], a[172:175], v[36:39], v[88:91]
    ds_read_b64_tr_b16 a[198:199], v1 offset:2336
    v_mfma_f32_16x16x32_bf16 v[92:95], a[176:179], v[36:39], v[92:95]
    ds_read_b64_tr_b16 a[200:201], v2 offset:1536
    v_mfma_f32_16x16x32_bf16 v[72:75], a[156:159], v[36:39], v[72:75]
    ds_read_b64_tr_b16 a[202:203], v2 offset:2304
    v_mfma_f32_16x16x32_bf16 v[76:79], a[160:163], v[36:39], v[76:79]
    s_add_u32 m0, s33, 13824
    s_mov_b64 exec, s[98:99]
    buffer_load_dwordx4 v13, s[4:7], s20 offen lds
    s_mov_b64 exec, -1
    v_mfma_f32_16x16x32_bf16 v[80:83], a[164:167], v[36:39], v[80:83]
    ds_read_b64_tr_b16 a[180:181], v1 offset:0
    v_mfma_f32_16x16x32_bf16 v[60:63], a[144:147], v[36:39], v[60:63]
    ds_read_b64_tr_b16 a[182:183], v1 offset:768
    v_mfma_f32_16x16x32_bf16 v[64:67], a[148:151], v[36:39], v[64:67]
    ds_read_b64_tr_b16 a[184:185], v1 offset:32
    v_mfma_f32_16x16x32_bf16 v[68:71], a[152:155], v[36:39], v[68:71]
    s_add_u32 m0, s33, 38016
    s_mov_b64 exec, s[98:99]
    buffer_load_dwordx4 v13, s[4:7], s27 offen lds
    s_mov_b64 exec, -1
    ds_read_b128 v[32:35], v205 offset:6912
    s_waitcnt lgkmcnt(15)
    v_mfma_f32_16x16x32_bf16 v[60:63], a[168:171], v[40:43], v[60:63]
    ds_read_b64_tr_b16 a[186:187], v1 offset:800
    v_mfma_f32_16x16x32_bf16 v[64:67], a[172:175], v[40:43], v[64:67]
    ds_read_b64_tr_b16 a[188:189], v2 offset:0
    v_mfma_f32_16x16x32_bf16 v[68:71], a[176:179], v[40:43], v[68:71]
    ds_read_b64_tr_b16 a[190:191], v2 offset:768
    v_mfma_f32_16x16x32_bf16 v[48:51], a[156:159], v[40:43], v[48:51]
    v_mfma_f32_16x16x32_bf16 v[52:55], a[160:163], v[40:43], v[52:55]
    v_mfma_f32_16x16x32_bf16 v[56:59], a[164:167], v[40:43], v[56:59]
    ds_read_b128 v[36:39], v205 offset:10368
    s_waitcnt lgkmcnt(11)
    v_mfma_f32_16x16x32_bf16 v[48:51], a[168:171], v[44:47], v[48:51]
    v_mfma_f32_16x16x32_bf16 v[52:55], a[172:175], v[44:47], v[52:55]
    v_mfma_f32_16x16x32_bf16 v[56:59], a[176:179], v[44:47], v[56:59]
    ds_read_b128 v[40:43], v205 offset:3456
    s_waitcnt vmcnt(7)
    s_barrier
    s_waitcnt lgkmcnt(5)
    v_mfma_f32_16x16x32_bf16 v[72:75], a[204:207], v[32:35], v[72:75]
    s_add_u32 m0, s33, 17280
    s_mov_b64 exec, s[98:99]
    buffer_load_dwordx4 v13, s[4:7], s21 offen lds
    s_mov_b64 exec, -1
    v_mfma_f32_16x16x32_bf16 v[76:79], a[208:211], v[32:35], v[76:79]
    ds_read_b64_tr_b16 a[240:241], v1 offset:21632
    v_mfma_f32_16x16x32_bf16 v[80:83], a[212:215], v[32:35], v[80:83]
    ds_read_b64_tr_b16 a[242:243], v1 offset:22400
    v_mfma_f32_16x16x32_bf16 v[60:63], a[192:195], v[32:35], v[60:63]
    ds_read_b64_tr_b16 a[244:245], v1 offset:21664
    v_mfma_f32_16x16x32_bf16 v[64:67], a[196:199], v[32:35], v[64:67]
    ds_read_b64_tr_b16 a[246:247], v1 offset:22432
    v_mfma_f32_16x16x32_bf16 v[68:71], a[200:203], v[32:35], v[68:71]
    ds_read_b64_tr_b16 a[248:249], v2 offset:21632
    v_mfma_f32_16x16x32_bf16 v[48:51], a[180:183], v[32:35], v[48:51]
    s_add_u32 m0, s33, 41472
    s_mov_b64 exec, s[98:99]
    buffer_load_dwordx4 v13, s[4:7], s28 offen lds
    s_mov_b64 exec, -1
    s_waitcnt lgkmcnt(9)
    v_mfma_f32_16x16x32_bf16 v[52:55], a[184:187], v[32:35], v[52:55]
    ds_read_b64_tr_b16 a[250:251], v2 offset:22400
    s_waitcnt lgkmcnt(8)
    v_mfma_f32_16x16x32_bf16 v[56:59], a[188:191], v[32:35], v[56:59]
    ds_read_b64_tr_b16 a[228:229], v1 offset:20096
    ds_read_b128 v[44:47], v205 offset:0
    s_waitcnt lgkmcnt(9)
    v_mfma_f32_16x16x32_bf16 v[84:87], a[204:207], v[36:39], v[84:87]
    ds_read_b64_tr_b16 a[230:231], v1 offset:20864
    v_mfma_f32_16x16x32_bf16 v[88:91], a[208:211], v[36:39], v[88:91]
    ds_read_b64_tr_b16 a[232:233], v1 offset:20128
    v_mfma_f32_16x16x32_bf16 v[92:95], a[212:215], v[36:39], v[92:95]
    ds_read_b64_tr_b16 a[234:235], v1 offset:20896
    v_mfma_f32_16x16x32_bf16 v[72:75], a[192:195], v[36:39], v[72:75]
    s_add_u32 m0, s33, 20736
    s_mov_b64 exec, s[98:99]
    buffer_load_dwordx4 v13, s[4:7], s22 offen lds
    s_mov_b64 exec, -1
    v_mfma_f32_16x16x32_bf16 v[76:79], a[196:199], v[36:39], v[76:79]
    ds_read_b64_tr_b16 a[236:237], v2 offset:20096
    v_mfma_f32_16x16x32_bf16 v[80:83], a[200:203], v[36:39], v[80:83]
    ds_read_b64_tr_b16 a[238:239], v2 offset:20864
    v_mfma_f32_16x16x32_bf16 v[60:63], a[180:183], v[36:39], v[60:63]
    ds_read_b64_tr_b16 a[216:217], v1 offset:18560
    v_mfma_f32_16x16x32_bf16 v[64:67], a[184:187], v[36:39], v[64:67]
    ds_read_b64_tr_b16 a[218:219], v1 offset:19328
    v_mfma_f32_16x16x32_bf16 v[68:71], a[188:191], v[36:39], v[68:71]
    ds_read_b64_tr_b16 a[220:221], v1 offset:18592
    ds_read_b128 v[32:35], v206 offset:6912
    s_waitcnt lgkmcnt(15)
    v_mfma_f32_16x16x32_bf16 v[60:63], a[204:207], v[40:43], v[60:63]
    s_add_u32 m0, s33, 44928
    s_mov_b64 exec, s[98:99]
    buffer_load_dwordx4 v13, s[4:7], s29 offen lds
    s_mov_b64 exec, -1
    v_mfma_f32_16x16x32_bf16 v[64:67], a[208:211], v[40:43], v[64:67]
    ds_read_b64_tr_b16 a[222:223], v1 offset:19360
    v_mfma_f32_16x16x32_bf16 v[68:71], a[212:215], v[40:43], v[68:71]
    ds_read_b64_tr_b16 a[224:225], v2 offset:18560
    v_mfma_f32_16x16x32_bf16 v[48:51], a[192:195], v[40:43], v[48:51]
    ds_read_b64_tr_b16 a[226:227], v2 offset:19328
    v_mfma_f32_16x16x32_bf16 v[52:55], a[196:199], v[40:43], v[52:55]
    ds_read_b64_tr_b16 v[152:153], v1 offset:40192
    v_mfma_f32_16x16x32_bf16 v[56:59], a[200:203], v[40:43], v[56:59]
    ds_read_b64_tr_b16 v[154:155], v1 offset:40960
    ds_read_b128 v[36:39], v206 offset:10368
    s_waitcnt lgkmcnt(15)
    v_mfma_f32_16x16x32_bf16 v[48:51], a[204:207], v[44:47], v[48:51]
    s_add_u32 m0, s33, 48384
    s_mov_b64 exec, s[98:99]
    buffer_load_dwordx4 v13, s[4:7], s30 offen lds
    s_mov_b64 exec, -1
    v_mfma_f32_16x16x32_bf16 v[52:55], a[208:211], v[44:47], v[52:55]
    ds_read_b64_tr_b16 v[156:157], v1 offset:40224
    v_mfma_f32_16x16x32_bf16 v[56:59], a[212:215], v[44:47], v[56:59]
    ds_read_b64_tr_b16 v[158:159], v1 offset:40992
    ds_read_b128 v[40:43], v206 offset:3456
    s_waitcnt lgkmcnt(9)
    v_mfma_f32_16x16x32_bf16 v[72:75], a[240:243], v[32:35], v[72:75]
    ds_read_b64_tr_b16 v[160:161], v2 offset:40192
    v_mfma_f32_16x16x32_bf16 v[76:79], a[244:247], v[32:35], v[76:79]
    ds_read_b64_tr_b16 v[162:163], v2 offset:40960
    v_mfma_f32_16x16x32_bf16 v[80:83], a[248:251], v[32:35], v[80:83]
    ds_read_b64_tr_b16 v[140:141], v1 offset:38656
    v_mfma_f32_16x16x32_bf16 v[60:63], a[228:231], v[32:35], v[60:63]
    s_add_u32 m0, s33, 51840
    s_mov_b64 exec, s[98:99]
    buffer_load_dwordx4 v13, s[4:7], s31 offen lds
    s_mov_b64 exec, -1
    v_mfma_f32_16x16x32_bf16 v[64:67], a[232:235], v[32:35], v[64:67]
    ds_read_b64_tr_b16 v[142:143], v1 offset:39424
    v_mfma_f32_16x16x32_bf16 v[68:71], a[236:239], v[32:35], v[68:71]
    ds_read_b64_tr_b16 v[144:145], v1 offset:38688
    v_mfma_f32_16x16x32_bf16 v[48:51], a[216:219], v[32:35], v[48:51]
    ds_read_b64_tr_b16 v[146:147], v1 offset:39456
    s_waitcnt lgkmcnt(14)
    v_mfma_f32_16x16x32_bf16 v[52:55], a[220:223], v[32:35], v[52:55]
    ds_read_b64_tr_b16 v[148:149], v2 offset:38656
    s_waitcnt lgkmcnt(13)
    v_mfma_f32_16x16x32_bf16 v[56:59], a[224:227], v[32:35], v[56:59]
    ds_read_b64_tr_b16 v[150:151], v2 offset:39424
    ds_read_b128 v[44:47], v206 offset:0
    s_waitcnt lgkmcnt(12)
    v_mfma_f32_16x16x32_bf16 v[84:87], a[240:243], v[36:39], v[84:87]
    ds_read_b64_tr_b16 a[252:253], v1 offset:37120
    v_mfma_f32_16x16x32_bf16 v[88:91], a[244:247], v[36:39], v[88:91]
    ds_read_b64_tr_b16 a[254:255], v1 offset:37888
    v_mfma_f32_16x16x32_bf16 v[92:95], a[248:251], v[36:39], v[92:95]
    ds_read_b64_tr_b16 v[132:133], v1 offset:37152
    v_mfma_f32_16x16x32_bf16 v[72:75], a[228:231], v[36:39], v[72:75]
    ds_read_b64_tr_b16 v[134:135], v1 offset:37920
    v_mfma_f32_16x16x32_bf16 v[76:79], a[232:235], v[36:39], v[76:79]
    ds_read_b64_tr_b16 v[136:137], v2 offset:37120
    v_mfma_f32_16x16x32_bf16 v[80:83], a[236:239], v[36:39], v[80:83]
    ds_read_b64_tr_b16 v[138:139], v2 offset:37888
    v_mfma_f32_16x16x32_bf16 v[60:63], a[216:219], v[36:39], v[60:63]
    v_mfma_f32_16x16x32_bf16 v[64:67], a[220:223], v[36:39], v[64:67]
    v_mfma_f32_16x16x32_bf16 v[68:71], a[224:227], v[36:39], v[68:71]
    ds_read_b128 v[32:35], v207 offset:6912
    s_waitcnt lgkmcnt(15)
    v_mfma_f32_16x16x32_bf16 v[60:63], a[240:243], v[40:43], v[60:63]
    v_mfma_f32_16x16x32_bf16 v[64:67], a[244:247], v[40:43], v[64:67]
    v_mfma_f32_16x16x32_bf16 v[68:71], a[248:251], v[40:43], v[68:71]
    v_mfma_f32_16x16x32_bf16 v[48:51], a[228:231], v[40:43], v[48:51]
    v_mfma_f32_16x16x32_bf16 v[52:55], a[232:235], v[40:43], v[52:55]
    v_mfma_f32_16x16x32_bf16 v[56:59], a[236:239], v[40:43], v[56:59]
    ds_read_b128 v[36:39], v207 offset:10368
    s_waitcnt lgkmcnt(8)
    v_mfma_f32_16x16x32_bf16 v[48:51], a[240:243], v[44:47], v[48:51]
    v_mfma_f32_16x16x32_bf16 v[52:55], a[244:247], v[44:47], v[52:55]
    v_mfma_f32_16x16x32_bf16 v[56:59], a[248:251], v[44:47], v[56:59]
    ds_read_b128 v[40:43], v207 offset:3456
    s_waitcnt vmcnt(6)
    s_barrier
    s_waitcnt lgkmcnt(2)
    v_mfma_f32_16x16x32_bf16 v[72:75], v[152:155], v[32:35], v[72:75]
    ds_read_b64_tr_b16 v[188:189], v3 offset:3072
    v_mfma_f32_16x16x32_bf16 v[76:79], v[156:159], v[32:35], v[76:79]
    ds_read_b64_tr_b16 v[190:191], v3 offset:3840
    v_mfma_f32_16x16x32_bf16 v[80:83], v[160:163], v[32:35], v[80:83]
    ds_read_b64_tr_b16 v[192:193], v3 offset:3104
    v_mfma_f32_16x16x32_bf16 v[60:63], v[140:143], v[32:35], v[60:63]
    ds_read_b64_tr_b16 v[194:195], v3 offset:3872
    v_mfma_f32_16x16x32_bf16 v[64:67], v[144:147], v[32:35], v[64:67]
    ds_read_b64_tr_b16 v[196:197], v4 offset:3072
    v_mfma_f32_16x16x32_bf16 v[68:71], v[148:151], v[32:35], v[68:71]
    ds_read_b64_tr_b16 v[198:199], v4 offset:3840
    v_mfma_f32_16x16x32_bf16 v[48:51], a[252:255], v[32:35], v[48:51]
    ds_read_b64_tr_b16 v[176:177], v3 offset:1536
    v_mfma_f32_16x16x32_bf16 v[52:55], v[132:135], v[32:35], v[52:55]
    ds_read_b64_tr_b16 v[178:179], v3 offset:2304
    v_mfma_f32_16x16x32_bf16 v[56:59], v[136:139], v[32:35], v[56:59]
    ds_read_b64_tr_b16 v[180:181], v3 offset:1568
    ds_read_b128 v[44:47], v207 offset:0
    s_waitcnt lgkmcnt(11)
    v_mfma_f32_16x16x32_bf16 v[84:87], v[152:155], v[36:39], v[84:87]
    ds_read_b64_tr_b16 v[182:183], v3 offset:2336
    v_mfma_f32_16x16x32_bf16 v[88:91], v[156:159], v[36:39], v[88:91]
    ds_read_b64_tr_b16 v[184:185], v4 offset:1536
    v_mfma_f32_16x16x32_bf16 v[92:95], v[160:163], v[36:39], v[92:95]
    ds_read_b64_tr_b16 v[186:187], v4 offset:2304
    v_mfma_f32_16x16x32_bf16 v[72:75], v[140:143], v[36:39], v[72:75]
    ds_read_b64_tr_b16 v[164:165], v3 offset:0
    v_mfma_f32_16x16x32_bf16 v[76:79], v[144:147], v[36:39], v[76:79]
    ds_read_b64_tr_b16 v[166:167], v3 offset:768
    v_mfma_f32_16x16x32_bf16 v[80:83], v[148:151], v[36:39], v[80:83]
    ds_read_b64_tr_b16 v[168:169], v3 offset:32
    v_mfma_f32_16x16x32_bf16 v[60:63], a[252:255], v[36:39], v[60:63]
    ds_read_b64_tr_b16 v[170:171], v3 offset:800
    v_mfma_f32_16x16x32_bf16 v[64:67], v[132:135], v[36:39], v[64:67]
    ds_read_b64_tr_b16 v[172:173], v4 offset:0
    v_mfma_f32_16x16x32_bf16 v[68:71], v[136:139], v[36:39], v[68:71]
    ds_read_b64_tr_b16 v[174:175], v4 offset:768
    ds_read_b128 v[32:35], v208 offset:0
    s_waitcnt lgkmcnt(15)
    v_mfma_f32_16x16x32_bf16 v[60:63], v[152:155], v[40:43], v[60:63]
    v_mfma_f32_16x16x32_bf16 v[64:67], v[156:159], v[40:43], v[64:67]
    v_mfma_f32_16x16x32_bf16 v[68:71], v[160:163], v[40:43], v[68:71]
    v_mfma_f32_16x16x32_bf16 v[48:51], v[140:143], v[40:43], v[48:51]
    v_mfma_f32_16x16x32_bf16 v[52:55], v[144:147], v[40:43], v[52:55]
    v_mfma_f32_16x16x32_bf16 v[56:59], v[148:151], v[40:43], v[56:59]
    ds_read_b128 v[36:39], v208 offset:3456
    s_waitcnt lgkmcnt(11)
    v_mfma_f32_16x16x32_bf16 v[48:51], v[152:155], v[44:47], v[48:51]
    v_mfma_f32_16x16x32_bf16 v[52:55], v[156:159], v[44:47], v[52:55]
    v_mfma_f32_16x16x32_bf16 v[56:59], v[160:163], v[44:47], v[56:59]
    ds_read_b128 v[40:43], v208 offset:6912
    s_waitcnt lgkmcnt(2)
    v_mfma_f32_16x16x32_bf16 v[48:51], v[188:191], v[32:35], v[48:51]
    v_mfma_f32_16x16x32_bf16 v[52:55], v[192:195], v[32:35], v[52:55]
    v_mfma_f32_16x16x32_bf16 v[56:59], v[196:199], v[32:35], v[56:59]
    ds_read_b128 v[44:47], v208 offset:10368
    s_waitcnt lgkmcnt(2)
    v_mfma_f32_16x16x32_bf16 v[60:63], v[188:191], v[36:39], v[60:63]
    v_mfma_f32_16x16x32_bf16 v[64:67], v[192:195], v[36:39], v[64:67]
    v_mfma_f32_16x16x32_bf16 v[68:71], v[196:199], v[36:39], v[68:71]
    v_mfma_f32_16x16x32_bf16 v[48:51], v[176:179], v[36:39], v[48:51]
    v_mfma_f32_16x16x32_bf16 v[52:55], v[180:183], v[36:39], v[52:55]
    v_mfma_f32_16x16x32_bf16 v[56:59], v[184:187], v[36:39], v[56:59]
    ds_read_b128 v[32:35], v200 offset:13824
    s_waitcnt lgkmcnt(2)
    v_mfma_f32_16x16x32_bf16 v[72:75], v[188:191], v[40:43], v[72:75]
    v_mfma_f32_16x16x32_bf16 v[76:79], v[192:195], v[40:43], v[76:79]
    v_mfma_f32_16x16x32_bf16 v[80:83], v[196:199], v[40:43], v[80:83]
    v_mfma_f32_16x16x32_bf16 v[60:63], v[176:179], v[40:43], v[60:63]
    v_mfma_f32_16x16x32_bf16 v[64:67], v[180:183], v[40:43], v[64:67]
    v_mfma_f32_16x16x32_bf16 v[68:71], v[184:187], v[40:43], v[68:71]
    v_mfma_f32_16x16x32_bf16 v[48:51], v[164:167], v[40:43], v[48:51]
    v_mfma_f32_16x16x32_bf16 v[52:55], v[168:171], v[40:43], v[52:55]
    v_mfma_f32_16x16x32_bf16 v[56:59], v[172:175], v[40:43], v[56:59]
    ds_read_b128 v[36:39], v201 offset:13824
    s_waitcnt lgkmcnt(2)
    v_mfma_f32_16x16x32_bf16 v[84:87], v[188:191], v[44:47], v[84:87]
    v_mfma_f32_16x16x32_bf16 v[88:91], v[192:195], v[44:47], v[88:91]
    v_mfma_f32_16x16x32_bf16 v[92:95], v[196:199], v[44:47], v[92:95]
    v_mfma_f32_16x16x32_bf16 v[72:75], v[176:179], v[44:47], v[72:75]
    v_mfma_f32_16x16x32_bf16 v[76:79], v[180:183], v[44:47], v[76:79]
    v_mfma_f32_16x16x32_bf16 v[80:83], v[184:187], v[44:47], v[80:83]
    v_mfma_f32_16x16x32_bf16 v[60:63], v[164:167], v[44:47], v[60:63]
    v_mfma_f32_16x16x32_bf16 v[64:67], v[168:171], v[44:47], v[64:67]
    v_mfma_f32_16x16x32_bf16 v[68:71], v[172:175], v[44:47], v[68:71]
    v_cvt_pk_bf16_f32 v16, v48, v49
    v_cvt_pk_bf16_f32 v17, v50, v51
    ds_read_b128 v[40:43], v202 offset:13824
    s_waitcnt lgkmcnt(2)
    v_mfma_f32_16x16x32_bf16 v[96:99], a[24:27], v[32:35], 0
    v_cvt_pk_bf16_f32 v18, v52, v53
    v_cvt_pk_bf16_f32 v19, v54, v55
    v_mfma_f32_16x16x32_bf16 v[100:103], a[28:31], v[32:35], 0
    v_cvt_pk_bf16_f32 v20, v56, v57
    v_cvt_pk_bf16_f32 v21, v58, v59
    v_mfma_f32_16x16x32_bf16 v[104:107], a[32:35], v[32:35], 0
    s_add_u32 s38, s35, 0
    v_permlane16_swap_b32 v16, v18
    v_mfma_f32_16x16x32_bf16 v[84:87], a[12:15], v[32:35], v[84:87]
    v_permlane16_swap_b32 v17, v19
    v_mfma_f32_16x16x32_bf16 v[88:91], a[16:19], v[32:35], v[88:91]
    buffer_store_dwordx2 v[20:21], v15, s[12:15], s38 offen nt
    v_mfma_f32_16x16x32_bf16 v[92:95], a[20:23], v[32:35], v[92:95]
    v_mfma_f32_16x16x32_bf16 v[72:75], a[0:3], v[32:35], v[72:75]
    buffer_store_dwordx4 v[16:19], v14, s[12:15], s38 offen nt
    v_mfma_f32_16x16x32_bf16 v[76:79], a[4:7], v[32:35], v[76:79]
    v_mfma_f32_16x16x32_bf16 v[80:83], a[8:11], v[32:35], v[80:83]
    v_cvt_pk_bf16_f32 v24, v60, v61
    v_cvt_pk_bf16_f32 v25, v62, v63
    ds_read_b128 v[44:47], v203 offset:13824
    s_waitcnt lgkmcnt(2)
    v_mfma_f32_16x16x32_bf16 v[96:99], a[60:63], v[36:39], v[96:99]
    v_cvt_pk_bf16_f32 v26, v64, v65
    v_cvt_pk_bf16_f32 v27, v66, v67
    v_mfma_f32_16x16x32_bf16 v[100:103], a[64:67], v[36:39], v[100:103]
    v_cvt_pk_bf16_f32 v28, v68, v69
    v_cvt_pk_bf16_f32 v29, v70, v71
    v_mfma_f32_16x16x32_bf16 v[104:107], a[68:71], v[36:39], v[104:107]
    s_add_u32 s38, s35, 43008
    v_permlane16_swap_b32 v24, v26
    v_mfma_f32_16x16x32_bf16 v[84:87], a[48:51], v[36:39], v[84:87]
    v_permlane16_swap_b32 v25, v27
    v_mfma_f32_16x16x32_bf16 v[88:91], a[52:55], v[36:39], v[88:91]
    buffer_store_dwordx2 v[28:29], v15, s[12:15], s38 offen nt
    v_mfma_f32_16x16x32_bf16 v[92:95], a[56:59], v[36:39], v[92:95]
    v_mfma_f32_16x16x32_bf16 v[72:75], a[36:39], v[36:39], v[72:75]
    buffer_store_dwordx4 v[24:27], v14, s[12:15], s38 offen nt
    v_mfma_f32_16x16x32_bf16 v[76:79], a[40:43], v[36:39], v[76:79]
    v_mfma_f32_16x16x32_bf16 v[80:83], a[44:47], v[36:39], v[80:83]
    ds_read_b128 v[32:35], v204 offset:13824
    s_waitcnt lgkmcnt(2)
    v_mfma_f32_16x16x32_bf16 v[96:99], a[96:99], v[40:43], v[96:99]
    v_mfma_f32_16x16x32_bf16 v[100:103], a[100:103], v[40:43], v[100:103]
    v_mfma_f32_16x16x32_bf16 v[104:107], a[104:107], v[40:43], v[104:107]
    v_mfma_f32_16x16x32_bf16 v[84:87], a[84:87], v[40:43], v[84:87]
    v_mfma_f32_16x16x32_bf16 v[88:91], a[88:91], v[40:43], v[88:91]
    v_mfma_f32_16x16x32_bf16 v[92:95], a[92:95], v[40:43], v[92:95]
    v_mfma_f32_16x16x32_bf16 v[72:75], a[72:75], v[40:43], v[72:75]
    v_mfma_f32_16x16x32_bf16 v[76:79], a[76:79], v[40:43], v[76:79]
    v_mfma_f32_16x16x32_bf16 v[80:83], a[80:83], v[40:43], v[80:83]
    ds_read_b128 v[36:39], v205 offset:13824
    s_waitcnt lgkmcnt(2)
    v_mfma_f32_16x16x32_bf16 v[96:99], a[132:135], v[44:47], v[96:99]
    v_mfma_f32_16x16x32_bf16 v[100:103], a[136:139], v[44:47], v[100:103]
    v_mfma_f32_16x16x32_bf16 v[104:107], a[140:143], v[44:47], v[104:107]
    v_mfma_f32_16x16x32_bf16 v[84:87], a[120:123], v[44:47], v[84:87]
    v_mfma_f32_16x16x32_bf16 v[88:91], a[124:127], v[44:47], v[88:91]
    v_mfma_f32_16x16x32_bf16 v[92:95], a[128:131], v[44:47], v[92:95]
    v_mfma_f32_16x16x32_bf16 v[72:75], a[108:111], v[44:47], v[72:75]
    v_mfma_f32_16x16x32_bf16 v[76:79], a[112:115], v[44:47], v[76:79]
    v_mfma_f32_16x16x32_bf16 v[80:83], a[116:119], v[44:47], v[80:83]
    ds_read_b128 v[40:43], v206 offset:13824
    s_waitcnt lgkmcnt(2)
    v_mfma_f32_16x16x32_bf16 v[96:99], a[168:171], v[32:35], v[96:99]
    v_mfma_f32_16x16x32_bf16 v[100:103], a[172:175], v[32:35], v[100:103]
    v_mfma_f32_16x16x32_bf16 v[104:107], a[176:179], v[32:35], v[104:107]
    v_mfma_f32_16x16x32_bf16 v[84:87], a[156:159], v[32:35], v[84:87]
    v_mfma_f32_16x16x32_bf16 v[88:91], a[160:163], v[32:35], v[88:91]
    v_mfma_f32_16x16x32_bf16 v[92:95], a[164:167], v[32:35], v[92:95]
    v_mfma_f32_16x16x32_bf16 v[72:75], a[144:147], v[32:35], v[72:75]
    v_mfma_f32_16x16x32_bf16 v[76:79], a[148:151], v[32:35], v[76:79]
    v_mfma_f32_16x16x32_bf16 v[80:83], a[152:155], v[32:35], v[80:83]
    ds_read_b128 v[44:47], v207 offset:13824
    s_waitcnt lgkmcnt(2)
    v_mfma_f32_16x16x32_bf16 v[96:99], a[204:207], v[36:39], v[96:99]
    v_mfma_f32_16x16x32_bf16 v[100:103], a[208:211], v[36:39], v[100:103]
    v_mfma_f32_16x16x32_bf16 v[104:107], a[212:215], v[36:39], v[104:107]
    v_mfma_f32_16x16x32_bf16 v[84:87], a[192:195], v[36:39], v[84:87]
    v_mfma_f32_16x16x32_bf16 v[88:91], a[196:199], v[36:39], v[88:91]
    v_mfma_f32_16x16x32_bf16 v[92:95], a[200:203], v[36:39], v[92:95]
    v_mfma_f32_16x16x32_bf16 v[72:75], a[180:183], v[36:39], v[72:75]
    v_mfma_f32_16x16x32_bf16 v[76:79], a[184:187], v[36:39], v[76:79]
    v_mfma_f32_16x16x32_bf16 v[80:83], a[188:191], v[36:39], v[80:83]
    ds_read_b128 v[32:35], v208 offset:13824
    s_waitcnt vmcnt(4)
    s_barrier
    s_waitcnt lgkmcnt(2)
    v_mfma_f32_16x16x32_bf16 v[96:99], a[240:243], v[40:43], v[96:99]
    v_mfma_f32_16x16x32_bf16 v[100:103], a[244:247], v[40:43], v[100:103]
    v_mfma_f32_16x16x32_bf16 v[104:107], a[248:251], v[40:43], v[104:107]
    v_mfma_f32_16x16x32_bf16 v[84:87], a[228:231], v[40:43], v[84:87]
    v_mfma_f32_16x16x32_bf16 v[88:91], a[232:235], v[40:43], v[88:91]
    v_mfma_f32_16x16x32_bf16 v[92:95], a[236:239], v[40:43], v[92:95]
    v_mfma_f32_16x16x32_bf16 v[72:75], a[216:219], v[40:43], v[72:75]
    v_mfma_f32_16x16x32_bf16 v[76:79], a[220:223], v[40:43], v[76:79]
    v_mfma_f32_16x16x32_bf16 v[80:83], a[224:227], v[40:43], v[80:83]
    ds_read_b128 v[36:39], v200 offset:27648
    s_waitcnt lgkmcnt(2)
    v_mfma_f32_16x16x32_bf16 v[96:99], v[152:155], v[44:47], v[96:99]
    v_mfma_f32_16x16x32_bf16 v[100:103], v[156:159], v[44:47], v[100:103]
    v_mfma_f32_16x16x32_bf16 v[104:107], v[160:163], v[44:47], v[104:107]
    v_mfma_f32_16x16x32_bf16 v[84:87], v[140:143], v[44:47], v[84:87]
    v_mfma_f32_16x16x32_bf16 v[88:91], v[144:147], v[44:47], v[88:91]
    v_mfma_f32_16x16x32_bf16 v[92:95], v[148:151], v[44:47], v[92:95]
    v_mfma_f32_16x16x32_bf16 v[72:75], a[252:255], v[44:47], v[72:75]
    v_mfma_f32_16x16x32_bf16 v[76:79], v[132:135], v[44:47], v[76:79]
    v_mfma_f32_16x16x32_bf16 v[80:83], v[136:139], v[44:47], v[80:83]
    ds_read_b128 v[40:43], v200 offset:17280
    s_waitcnt lgkmcnt(2)
    v_mfma_f32_16x16x32_bf16 v[96:99], v[188:191], v[32:35], v[96:99]
    v_mfma_f32_16x16x32_bf16 v[100:103], v[192:195], v[32:35], v[100:103]
    v_mfma_f32_16x16x32_bf16 v[104:107], v[196:199], v[32:35], v[104:107]
    v_mfma_f32_16x16x32_bf16 v[84:87], v[176:179], v[32:35], v[84:87]
    v_mfma_f32_16x16x32_bf16 v[88:91], v[180:183], v[32:35], v[88:91]
    v_mfma_f32_16x16x32_bf16 v[92:95], v[184:187], v[32:35], v[92:95]
    v_mfma_f32_16x16x32_bf16 v[72:75], v[164:167], v[32:35], v[72:75]
    v_mfma_f32_16x16x32_bf16 v[76:79], v[168:171], v[32:35], v[76:79]
    v_mfma_f32_16x16x32_bf16 v[80:83], v[172:175], v[32:35], v[80:83]
    ds_read_b128 v[44:47], v200 offset:24192
    s_waitcnt lgkmcnt(2)
    v_mfma_f32_16x16x32_bf16 v[128:131], a[8:11], v[36:39], 0
    ds_read_b128 v[32:35], v200 offset:20736
    s_waitcnt lgkmcnt(2)
    v_mfma_f32_16x16x32_bf16 v[116:119], a[32:35], v[40:43], 0
    v_mfma_f32_16x16x32_bf16 v[104:107], a[20:23], v[40:43], v[104:107]
    v_mfma_f32_16x16x32_bf16 v[92:95], a[8:11], v[40:43], v[92:95]
    ds_read_b128 v[36:39], v201 offset:27648
    s_waitcnt lgkmcnt(2)
    v_mfma_f32_16x16x32_bf16 v[128:131], a[20:23], v[44:47], v[128:131]
    v_mfma_f32_16x16x32_bf16 v[116:119], a[8:11], v[44:47], v[116:119]
    ds_read_b128 v[40:43], v201 offset:17280
    s_waitcnt lgkmcnt(2)
    v_mfma_f32_16x16x32_bf16 v[128:131], a[32:35], v[32:35], v[128:131]
    v_mfma_f32_16x16x32_bf16 v[116:119], a[20:23], v[32:35], v[116:119]
    v_mfma_f32_16x16x32_bf16 v[104:107], a[8:11], v[32:35], v[104:107]
    v_cvt_pk_bf16_f32 v16, v72, v73
    v_cvt_pk_bf16_f32 v17, v74, v75
    ds_read_b128 v[44:47], v201 offset:24192
    s_waitcnt lgkmcnt(2)
    v_mfma_f32_16x16x32_bf16 v[128:131], a[44:47], v[36:39], v[128:131]
    v_cvt_pk_bf16_f32 v18, v76, v77
    v_cvt_pk_bf16_f32 v19, v78, v79
    ds_read_b128 v[32:35], v201 offset:20736
    s_waitcnt lgkmcnt(2)
    v_mfma_f32_16x16x32_bf16 v[116:119], a[68:71], v[40:43], v[116:119]
    v_cvt_pk_bf16_f32 v20, v80, v81
    v_cvt_pk_bf16_f32 v21, v82, v83
    v_mfma_f32_16x16x32_bf16 v[104:107], a[56:59], v[40:43], v[104:107]
    s_add_u32 s38, s35, 86016
    v_permlane16_swap_b32 v16, v18
    v_mfma_f32_16x16x32_bf16 v[92:95], a[44:47], v[40:43], v[92:95]
    v_permlane16_swap_b32 v17, v19
    ds_read_b128 v[36:39], v202 offset:27648
    s_waitcnt lgkmcnt(2)
    v_mfma_f32_16x16x32_bf16 v[128:131], a[56:59], v[44:47], v[128:131]
    buffer_store_dwordx2 v[20:21], v15, s[12:15], s38 offen nt
    v_mfma_f32_16x16x32_bf16 v[116:119], a[44:47], v[44:47], v[116:119]
    ds_read_b128 v[40:43], v202 offset:17280
    s_waitcnt lgkmcnt(2)
    v_mfma_f32_16x16x32_bf16 v[128:131], a[68:71], v[32:35], v[128:131]
    buffer_store_dwordx4 v[16:19], v14, s[12:15], s38 offen nt
    v_mfma_f32_16x16x32_bf16 v[116:119], a[56:59], v[32:35], v[116:119]
    v_mfma_f32_16x16x32_bf16 v[104:107], a[44:47], v[32:35], v[104:107]
    ds_read_b128 v[44:47], v202 offset:24192
    s_waitcnt lgkmcnt(2)
    v_mfma_f32_16x16x32_bf16 v[128:131], a[80:83], v[36:39], v[128:131]
    ds_read_b128 v[32:35], v202 offset:20736
    s_waitcnt lgkmcnt(2)
    v_mfma_f32_16x16x32_bf16 v[116:119], a[104:107], v[40:43], v[116:119]
    v_mfma_f32_16x16x32_bf16 v[104:107], a[92:95], v[40:43], v[104:107]
    v_mfma_f32_16x16x32_bf16 v[92:95], a[80:83], v[40:43], v[92:95]
    ds_read_b128 v[36:39], v203 offset:27648
    s_waitcnt lgkmcnt(2)
    v_mfma_f32_16x16x32_bf16 v[128:131], a[92:95], v[44:47], v[128:131]
    v_mfma_f32_16x16x32_bf16 v[116:119], a[80:83], v[44:47], v[116:119]
    ds_read_b128 v[40:43], v203 offset:17280
    s_waitcnt lgkmcnt(2)
    v_mfma_f32_16x16x32_bf16 v[128:131], a[104:107], v[32:35], v[128:131]
    v_mfma_f32_16x16x32_bf16 v[116:119], a[92:95], v[32:35], v[116:119]
    v_mfma_f32_16x16x32_bf16 v[104:107], a[80:83], v[32:35], v[104:107]
    ds_read_b128 v[44:47], v203 offset:24192
    s_waitcnt lgkmcnt(2)
    v_mfma_f32_16x16x32_bf16 v[128:131], a[116:119], v[36:39], v[128:131]
    ds_read_b128 v[32:35], v203 offset:20736
    s_waitcnt lgkmcnt(2)
    v_mfma_f32_16x16x32_bf16 v[116:119], a[140:143], v[40:43], v[116:119]
    v_mfma_f32_16x16x32_bf16 v[104:107], a[128:131], v[40:43], v[104:107]
    v_mfma_f32_16x16x32_bf16 v[92:95], a[116:119], v[40:43], v[92:95]
    ds_read_b128 v[36:39], v204 offset:27648
    s_waitcnt lgkmcnt(2)
    v_mfma_f32_16x16x32_bf16 v[128:131], a[128:131], v[44:47], v[128:131]
    v_mfma_f32_16x16x32_bf16 v[116:119], a[116:119], v[44:47], v[116:119]
    ds_read_b128 v[40:43], v204 offset:17280
    s_waitcnt lgkmcnt(2)
    v_mfma_f32_16x16x32_bf16 v[128:131], a[140:143], v[32:35], v[128:131]
    v_mfma_f32_16x16x32_bf16 v[116:119], a[128:131], v[32:35], v[116:119]
    v_mfma_f32_16x16x32_bf16 v[104:107], a[116:119], v[32:35], v[104:107]
    ds_read_b128 v[44:47], v204 offset:24192
    s_waitcnt lgkmcnt(2)
    v_mfma_f32_16x16x32_bf16 v[128:131], a[152:155], v[36:39], v[128:131]
    ds_read_b128 v[32:35], v204 offset:20736
    s_waitcnt lgkmcnt(2)
    v_mfma_f32_16x16x32_bf16 v[116:119], a[176:179], v[40:43], v[116:119]
    v_mfma_f32_16x16x32_bf16 v[104:107], a[164:167], v[40:43], v[104:107]
    v_mfma_f32_16x16x32_bf16 v[92:95], a[152:155], v[40:43], v[92:95]
L_pad1:
    s_cbranch_vccnz L_main
    ds_read_b128 v[36:39], v205 offset:27648
    s_waitcnt lgkmcnt(2)
    v_mfma_f32_16x16x32_bf16 v[128:131], a[164:167], v[44:47], v[128:131]
    v_mfma_f32_16x16x32_bf16 v[116:119], a[152:155], v[44:47], v[116:119]
    ds_read_b128 v[40:43], v205 offset:17280
    s_waitcnt lgkmcnt(2)
    v_mfma_f32_16x16x32_bf16 v[128:131], a[176:179], v[32:35], v[128:131]
    v_mfma_f32_16x16x32_bf16 v[116:119], a[164:167], v[32:35], v[116:119]
    v_mfma_f32_16x16x32_bf16 v[104:107], a[152:155], v[32:35], v[104:107]
    ds_read_b128 v[44:47], v205 offset:24192
    s_waitcnt lgkmcnt(2)
    v_mfma_f32_16x16x32_bf16 v[128:131], a[188:191], v[36:39], v[128:131]
    ds_read_b128 v[32:35], v205 offset:20736
    s_waitcnt lgkmcnt(2)
    v_mfma_f32_16x16x32_bf16 v[116:119], a[212:215], v[40:43], v[116:119]
    v_mfma_f32_16x16x32_bf16 v[104:107], a[200:203], v[40:43], v[104:107]
    v_mfma_f32_16x16x32_bf16 v[92:95], a[188:191], v[40:43], v[92:95]
    ds_read_b128 v[36:39], v206 offset:27648
    s_waitcnt lgkmcnt(2)
    v_mfma_f32_16x16x32_bf16 v[128:131], a[200:203], v[44:47], v[128:131]
    v_mfma_f32_16x16x32_bf16 v[116:119], a[188:191], v[44:47], v[116:119]
    ds_read_b128 v[40:43], v206 offset:17280
    s_waitcnt lgkmcnt(2)
    v_mfma_f32_16x16x32_bf16 v[128:131], a[212:215], v[32:35], v[128:131]
    v_mfma_f32_16x16x32_bf16 v[116:119], a[200:203], v[32:35], v[116:119]
    v_mfma_f32_16x16x32_bf16 v[104:107], a[188:191], v[32:35], v[104:107]
    ds_read_b128 v[44:47], v206 offset:24192
    s_waitcnt lgkmcnt(2)
    v_mfma_f32_16x16x32_bf16 v[128:131], a[224:227], v[36:39], v[128:131]
    ds_read_b128 v[32:35], v206 offset:20736
    s_waitcnt lgkmcnt(2)
    v_mfma_f32_16x16x32_bf16 v[116:119], a[248:251], v[40:43], v[116:119]
    v_mfma_f32_16x16x32_bf16 v[104:107], a[236:239], v[40:43], v[104:107]
    v_mfma_f32_16x16x32_bf16 v[92:95], a[224:227], v[40:43], v[92:95]
    ds_read_b128 v[36:39], v207 offset:27648
    s_waitcnt lgkmcnt(2)
    v_mfma_f32_16x16x32_bf16 v[128:131], a[236:239], v[44:47], v[128:131]
    v_mfma_f32_16x16x32_bf16 v[116:119], a[224:227], v[44:47], v[116:119]
    ds_read_b128 v[40:43], v207 offset:17280
    s_waitcnt lgkmcnt(2)
    v_mfma_f32_16x16x32_bf16 v[128:131], a[248:251], v[32:35], v[128:131]
    v_mfma_f32_16x16x32_bf16 v[116:119], a[236:239], v[32:35], v[116:119]
    v_mfma_f32_16x16x32_bf16 v[104:107], a[224:227], v[32:35], v[104:107]
    ds_read_b128 v[44:47], v207 offset:24192
    s_waitcnt lgkmcnt(2)
    v_mfma_f32_16x16x32_bf16 v[128:131], v[136:139], v[36:39], v[128:131]
    ds_read_b128 v[32:35], v207 offset:20736
    s_waitcnt lgkmcnt(2)
    v_mfma_f32_16x16x32_bf16 v[116:119], v[160:163], v[40:43], v[116:119]
    v_mfma_f32_16x16x32_bf16 v[104:107], v[148:151], v[40:43], v[104:107]
    v_mfma_f32_16x16x32_bf16 v[92:95], v[136:139], v[40:43], v[92:95]
    ds_read_b128 v[36:39], v208 offset:27648
    s_waitcnt lgkmcnt(2)
    v_mfma_f32_16x16x32_bf16 v[128:131], v[148:151], v[44:47], v[128:131]
    v_mfma_f32_16x16x32_bf16 v[116:119], v[136:139], v[44:47], v[116:119]
    ds_read_b128 v[40:43], v208 offset:17280
    s_waitcnt lgkmcnt(2)
    v_mfma_f32_16x16x32_bf16 v[128:131], v[160:163], v[32:35], v[128:131]
    v_mfma_f32_16x16x32_bf16 v[116:119], v[148:151], v[32:35], v[116:119]
    v_mfma_f32_16x16x32_bf16 v[104:107], v[136:139], v[32:35], v[104:107]
    ds_read_b128 v[44:47], v208 offset:24192
    s_waitcnt lgkmcnt(2)
    v_mfma_f32_16x16x32_bf16 v[128:131], v[172:175], v[36:39], v[128:131]
    ds_read_b128 v[32:35], v208 offset:20736
    s_waitcnt lgkmcnt(2)
    v_mfma_f32_16x16x32_bf16 v[116:119], v[196:199], v[40:43], v[116:119]
    v_mfma_f32_16x16x32_bf16 v[104:107], v[184:187], v[40:43], v[104:107]
    v_mfma_f32_16x16x32_bf16 v[92:95], v[172:175], v[40:43], v[92:95]
    ds_read_b128 v[36:39], v200 offset:17280
    s_waitcnt lgkmcnt(2)
    v_mfma_f32_16x16x32_bf16 v[128:131], v[184:187], v[44:47], v[128:131]
    v_mfma_f32_16x16x32_bf16 v[116:119], v[172:175], v[44:47], v[116:119]
    ds_read_b128 v[40:43], v201 offset:17280
    s_waitcnt lgkmcnt(2)
    v_mfma_f32_16x16x32_bf16 v[128:131], v[196:199], v[32:35], v[128:131]
    v_mfma_f32_16x16x32_bf16 v[116:119], v[184:187], v[32:35], v[116:119]
    v_mfma_f32_16x16x32_bf16 v[104:107], v[172:175], v[32:35], v[104:107]
    ds_read_b128 v[44:47], v202 offset:17280
    s_waitcnt lgkmcnt(2)
    v_mfma_f32_16x16x32_bf16 v[108:111], a[24:27], v[36:39], 0
    v_mfma_f32_16x16x32_bf16 v[112:115], a[28:31], v[36:39], 0
    v_mfma_f32_16x16x32_bf16 v[96:99], a[12:15], v[36:39], v[96:99]
    v_mfma_f32_16x16x32_bf16 v[100:103], a[16:19], v[36:39], v[100:103]
    v_cvt_pk_bf16_f32 v28, v92, v93
    v_cvt_pk_bf16_f32 v29, v94, v95
    v_mfma_f32_16x16x32_bf16 v[84:87], a[0:3], v[36:39], v[84:87]
    s_add_u32 s38, s35, 129024
    v_mfma_f32_16x16x32_bf16 v[88:91], a[4:7], v[36:39], v[88:91]
    buffer_store_dwordx2 v[28:29], v15, s[12:15], s38 offen nt
    ds_read_b128 v[32:35], v203 offset:17280
    s_waitcnt lgkmcnt(2)
    v_mfma_f32_16x16x32_bf16 v[108:111], a[60:63], v[40:43], v[108:111]
    v_cvt_pk_bf16_f32 v20, v128, v129
    v_cvt_pk_bf16_f32 v21, v130, v131
    v_mfma_f32_16x16x32_bf16 v[112:115], a[64:67], v[40:43], v[112:115]
    s_add_u32 s38, s35, 258048
    v_mfma_f32_16x16x32_bf16 v[96:99], a[48:51], v[40:43], v[96:99]
    buffer_store_dwordx2 v[20:21], v15, s[12:15], s38 offen nt
    v_mfma_f32_16x16x32_bf16 v[100:103], a[52:55], v[40:43], v[100:103]
    v_cvt_pk_bf16_f32 v28, v116, v117
    v_cvt_pk_bf16_f32 v29, v118, v119
    v_mfma_f32_16x16x32_bf16 v[84:87], a[36:39], v[40:43], v[84:87]
    s_add_u32 s38, s35, 215040
    v_mfma_f32_16x16x32_bf16 v[88:91], a[40:43], v[40:43], v[88:91]
    buffer_store_dwordx2 v[28:29], v15, s[12:15], s38 offen nt
    ds_read_b128 v[36:39], v204 offset:17280
    s_waitcnt lgkmcnt(2)
    v_mfma_f32_16x16x32_bf16 v[108:111], a[96:99], v[44:47], v[108:111]
    v_cvt_pk_bf16_f32 v20, v104, v105
    v_cvt_pk_bf16_f32 v21, v106, v107
    v_mfma_f32_16x16x32_bf16 v[112:115], a[100:103], v[44:47], v[112:115]
    s_add_u32 s38, s35, 172032
    v_mfma_f32_16x16x32_bf16 v[96:99], a[84:87], v[44:47], v[96:99]
    buffer_store_dwordx2 v[20:21], v15, s[12:15], s38 offen nt
    v_mfma_f32_16x16x32_bf16 v[100:103], a[88:91], v[44:47], v[100:103]
    v_mfma_f32_16x16x32_bf16 v[84:87], a[72:75], v[44:47], v[84:87]
    v_mfma_f32_16x16x32_bf16 v[88:91], a[76:79], v[44:47], v[88:91]
    ds_read_b128 v[40:43], v205 offset:17280
    s_waitcnt lgkmcnt(2)
    v_mfma_f32_16x16x32_bf16 v[108:111], a[132:135], v[32:35], v[108:111]
    v_mfma_f32_16x16x32_bf16 v[112:115], a[136:139], v[32:35], v[112:115]
    v_mfma_f32_16x16x32_bf16 v[96:99], a[120:123], v[32:35], v[96:99]
    v_mfma_f32_16x16x32_bf16 v[100:103], a[124:127], v[32:35], v[100:103]
    v_mfma_f32_16x16x32_bf16 v[84:87], a[108:111], v[32:35], v[84:87]
    v_mfma_f32_16x16x32_bf16 v[88:91], a[112:115], v[32:35], v[88:91]
    ds_read_b128 v[44:47], v206 offset:17280
    s_waitcnt lgkmcnt(2)
    v_mfma_f32_16x16x32_bf16 v[108:111], a[168:171], v[36:39], v[108:111]
    v_mfma_f32_16x16x32_bf16 v[112:115], a[172:175], v[36:39], v[112:115]
    v_mfma_f32_16x16x32_bf16 v[96:99], a[156:159], v[36:39], v[96:99]
    v_mfma_f32_16x16x32_bf16 v[100:103], a[160:163], v[36:39], v[100:103]
    v_mfma_f32_16x16x32_bf16 v[84:87], a[144:147], v[36:39], v[84:87]
    v_mfma_f32_16x16x32_bf16 v[88:91], a[148:151], v[36:39], v[88:91]
    ds_read_b128 v[32:35], v207 offset:17280
    s_waitcnt lgkmcnt(2)
    v_mfma_f32_16x16x32_bf16 v[108:111], a[204:207], v[40:43], v[108:111]
    v_mfma_f32_16x16x32_bf16 v[112:115], a[208:211], v[40:43], v[112:115]
    v_mfma_f32_16x16x32_bf16 v[96:99], a[192:195], v[40:43], v[96:99]
    v_mfma_f32_16x16x32_bf16 v[100:103], a[196:199], v[40:43], v[100:103]
    v_mfma_f32_16x16x32_bf16 v[84:87], a[180:183], v[40:43], v[84:87]
    v_mfma_f32_16x16x32_bf16 v[88:91], a[184:187], v[40:43], v[88:91]
    ds_read_b128 v[36:39], v208 offset:17280
    s_waitcnt lgkmcnt(2)
    v_mfma_f32_16x16x32_bf16 v[108:111], a[240:243], v[44:47], v[108:111]
    v_mfma_f32_16x16x32_bf16 v[112:115], a[244:247], v[44:47], v[112:115]
    v_mfma_f32_16x16x32_bf16 v[96:99], a[228:231], v[44:47], v[96:99]
    v_mfma_f32_16x16x32_bf16 v[100:103], a[232:235], v[44:47], v[100:103]
    v_mfma_f32_16x16x32_bf16 v[84:87], a[216:219], v[44:47], v[84:87]
    v_mfma_f32_16x16x32_bf16 v[88:91], a[220:223], v[44:47], v[88:91]
    ds_read_b128 v[40:43], v200 offset:20736
    s_waitcnt lgkmcnt(2)
    v_mfma_f32_16x16x32_bf16 v[108:111], v[152:155], v[32:35], v[108:111]
    v_mfma_f32_16x16x32_bf16 v[112:115], v[156:159], v[32:35], v[112:115]
    v_mfma_f32_16x16x32_bf16 v[96:99], v[140:143], v[32:35], v[96:99]
    v_mfma_f32_16x16x32_bf16 v[100:103], v[144:147], v[32:35], v[100:103]
    v_mfma_f32_16x16x32_bf16 v[84:87], a[252:255], v[32:35], v[84:87]
    v_mfma_f32_16x16x32_bf16 v[88:91], v[132:135], v[32:35], v[88:91]
    ds_read_b128 v[44:47], v201 offset:20736
    s_waitcnt lgkmcnt(2)
    v_mfma_f32_16x16x32_bf16 v[108:111], v[188:191], v[36:39], v[108:111]
    v_mfma_f32_16x16x32_bf16 v[112:115], v[192:195], v[36:39], v[112:115]
    v_mfma_f32_16x16x32_bf16 v[96:99], v[176:179], v[36:39], v[96:99]
    v_mfma_f32_16x16x32_bf16 v[100:103], v[180:183], v[36:39], v[100:103]
    v_mfma_f32_16x16x32_bf16 v[84:87], v[164:167], v[36:39], v[84:87]
    v_mfma_f32_16x16x32_bf16 v[88:91], v[168:171], v[36:39], v[88:91]
    ds_read_b128 v[32:35], v202 offset:20736
    s_waitcnt lgkmcnt(2)
    v_mfma_f32_16x16x32_bf16 v[108:111], a[12:15], v[40:43], v[108:111]
    v_mfma_f32_16x16x32_bf16 v[112:115], a[16:19], v[40:43], v[112:115]
    v_mfma_f32_16x16x32_bf16 v[96:99], a[0:3], v[40:43], v[96:99]
    v_mfma_f32_16x16x32_bf16 v[100:103], a[4:7], v[40:43], v[100:103]
    ds_read_b128 v[36:39], v203 offset:20736
    s_waitcnt lgkmcnt(2)
    v_mfma_f32_16x16x32_bf16 v[108:111], a[48:51], v[44:47], v[108:111]
    v_mfma_f32_16x16x32_bf16 v[112:115], a[52:55], v[44:47], v[112:115]
    v_mfma_f32_16x16x32_bf16 v[96:99], a[36:39], v[44:47], v[96:99]
    v_mfma_f32_16x16x32_bf16 v[100:103], a[40:43], v[44:47], v[100:103]
    ds_read_b128 v[40:43], v204 offset:20736
    s_waitcnt lgkmcnt(2)
    v_mfma_f32_16x16x32_bf16 v[108:111], a[84:87], v[32:35], v[108:111]
    v_cvt_pk_bf16_f32 v24, v84, v85
    v_cvt_pk_bf16_f32 v25, v86, v87
    v_mfma_f32_16x16x32_bf16 v[112:115], a[88:91], v[32:35], v[112:115]
    v_cvt_pk_bf16_f32 v26, v88, v89
    v_cvt_pk_bf16_f32 v27, v90, v91
    v_mfma_f32_16x16x32_bf16 v[96:99], a[72:75], v[32:35], v[96:99]
    s_add_u32 s38, s35, 129024
    v_permlane16_swap_b32 v24, v26
    v_mfma_f32_16x16x32_bf16 v[100:103], a[76:79], v[32:35], v[100:103]
    v_permlane16_swap_b32 v25, v27
    ds_read_b128 v[44:47], v205 offset:20736
    s_waitcnt lgkmcnt(2)
    v_mfma_f32_16x16x32_bf16 v[108:111], a[120:123], v[36:39], v[108:111]
    buffer_store_dwordx4 v[24:27], v14, s[12:15], s38 offen nt
    v_mfma_f32_16x16x32_bf16 v[112:115], a[124:127], v[36:39], v[112:115]
    v_mfma_f32_16x16x32_bf16 v[96:99], a[108:111], v[36:39], v[96:99]
    v_mfma_f32_16x16x32_bf16 v[100:103], a[112:115], v[36:39], v[100:103]
    ds_read_b128 v[32:35], v206 offset:20736
    s_waitcnt lgkmcnt(2)
    v_mfma_f32_16x16x32_bf16 v[108:111], a[156:159], v[40:43], v[108:111]
    v_mfma_f32_16x16x32_bf16 v[112:115], a[160:163], v[40:43], v[112:115]
    v_mfma_f32_16x16x32_bf16 v[96:99], a[144:147], v[40:43], v[96:99]
    v_mfma_f32_16x16x32_bf16 v[100:103], a[148:151], v[40:43], v[100:103]
    ds_read_b128 v[36:39], v207 offset:20736
    s_waitcnt lgkmcnt(2)
    v_mfma_f32_16x16x32_bf16 v[108:111], a[192:195], v[44:47], v[108:111]
    v_mfma_f32_16x16x32_bf16 v[112:115], a[196:199], v[44:47], v[112:115]
    v_mfma_f32_16x16x32_bf16 v[96:99], a[180:183], v[44:47], v[96:99]
    v_mfma_f32_16x16x32_bf16 v[100:103], a[184:187], v[44:47], v[100:103]
    ds_read_b128 v[40:43], v208 offset:20736
    s_waitcnt lgkmcnt(2)
    v_mfma_f32_16x16x32_bf16 v[108:111], a[228:231], v[32:35], v[108:111]
    v_mfma_f32_16x16x32_bf16 v[112:115], a[232:235], v[32:35], v[112:115]
    v_mfma_f32_16x16x32_bf16 v[96:99], a[216:219], v[32:35], v[96:99]
    v_mfma_f32_16x16x32_bf16 v[100:103], a[220:223], v[32:35], v[100:103]
    ds_read_b128 v[44:47], v200 offset:24192
    s_waitcnt lgkmcnt(2)
    v_mfma_f32_16x16x32_bf16 v[108:111], v[140:143], v[36:39], v[108:111]
    v_mfma_f32_16x16x32_bf16 v[112:115], v[144:147], v[36:39], v[112:115]
    v_mfma_f32_16x16x32_bf16 v[96:99], a[252:255], v[36:39], v[96:99]
    v_mfma_f32_16x16x32_bf16 v[100:103], v[132:135], v[36:39], v[100:103]
    ds_read_b128 v[32:35], v201 offset:24192
    s_waitcnt lgkmcnt(2)
    v_mfma_f32_16x16x32_bf16 v[108:111], v[176:179], v[40:43], v[108:111]
    v_mfma_f32_16x16x32_bf16 v[112:115], v[180:183], v[40:43], v[112:115]
    v_mfma_f32_16x16x32_bf16 v[96:99], v[164:167], v[40:43], v[96:99]
    v_mfma_f32_16x16x32_bf16 v[100:103], v[168:171], v[40:43], v[100:103]
    ds_read_b128 v[36:39], v202 offset:24192
    s_waitcnt lgkmcnt(2)
    v_mfma_f32_16x16x32_bf16 v[108:111], a[0:3], v[44:47], v[108:111]
    v_mfma_f32_16x16x32_bf16 v[112:115], a[4:7], v[44:47], v[112:115]
    ds_read_b128 v[40:43], v203 offset:24192
    s_waitcnt lgkmcnt(2)
    v_mfma_f32_16x16x32_bf16 v[108:111], a[36:39], v[32:35], v[108:111]
    v_mfma_f32_16x16x32_bf16 v[112:115], a[40:43], v[32:35], v[112:115]
    ds_read_b128 v[44:47], v204 offset:24192
    s_waitcnt lgkmcnt(2)
    v_mfma_f32_16x16x32_bf16 v[108:111], a[72:75], v[36:39], v[108:111]
    v_mfma_f32_16x16x32_bf16 v[112:115], a[76:79], v[36:39], v[112:115]
    ds_read_b128 v[32:35], v205 offset:24192
    s_waitcnt lgkmcnt(2)
    v_mfma_f32_16x16x32_bf16 v[108:111], a[108:111], v[40:43], v[108:111]
    v_mfma_f32_16x16x32_bf16 v[112:115], a[112:115], v[40:43], v[112:115]
    ds_read_b128 v[36:39], v206 offset:24192
    s_waitcnt lgkmcnt(2)
    v_mfma_f32_16x16x32_bf16 v[108:111], a[144:147], v[44:47], v[108:111]
    v_cvt_pk_bf16_f32 v16, v96, v97
    v_cvt_pk_bf16_f32 v17, v98, v99
    v_mfma_f32_16x16x32_bf16 v[112:115], a[148:151], v[44:47], v[112:115]
    v_cvt_pk_bf16_f32 v18, v100, v101
    v_cvt_pk_bf16_f32 v19, v102, v103
    ds_read_b128 v[40:43], v207 offset:24192
    s_waitcnt lgkmcnt(2)
    v_mfma_f32_16x16x32_bf16 v[108:111], a[180:183], v[32:35], v[108:111]
    s_add_u32 s38, s35, 172032
    v_permlane16_swap_b32 v16, v18
    v_mfma_f32_16x16x32_bf16 v[112:115], a[184:187], v[32:35], v[112:115]
    v_permlane16_swap_b32 v17, v19
    ds_read_b128 v[44:47], v208 offset:24192
    s_waitcnt lgkmcnt(2)
    v_mfma_f32_16x16x32_bf16 v[108:111], a[216:219], v[36:39], v[108:111]
    buffer_store_dwordx4 v[16:19], v14, s[12:15], s38 offen nt
    v_mfma_f32_16x16x32_bf16 v[112:115], a[220:223], v[36:39], v[112:115]
    ds_read_b128 v[32:35], v200 offset:20736
    s_waitcnt lgkmcnt(2)
    v_mfma_f32_16x16x32_bf16 v[108:111], a[252:255], v[40:43], v[108:111]
    v_mfma_f32_16x16x32_bf16 v[112:115], v[132:135], v[40:43], v[112:115]
    ds_read_b128 v[36:39], v200 offset:24192
    s_waitcnt lgkmcnt(2)
    v_mfma_f32_16x16x32_bf16 v[108:111], v[164:167], v[44:47], v[108:111]
    v_mfma_f32_16x16x32_bf16 v[112:115], v[168:171], v[44:47], v[112:115]
    ds_read_b128 v[40:43], v200 offset:27648
    s_waitcnt lgkmcnt(2)
    v_mfma_f32_16x16x32_bf16 v[120:123], a[24:27], v[32:35], 0
    v_mfma_f32_16x16x32_bf16 v[124:127], a[28:31], v[32:35], 0
    ds_read_b128 v[44:47], v201 offset:20736
    s_waitcnt lgkmcnt(2)
    v_mfma_f32_16x16x32_bf16 v[120:123], a[12:15], v[36:39], v[120:123]
    v_mfma_f32_16x16x32_bf16 v[124:127], a[16:19], v[36:39], v[124:127]
    ds_read_b128 v[32:35], v201 offset:24192
    s_waitcnt lgkmcnt(2)
    v_mfma_f32_16x16x32_bf16 v[120:123], a[0:3], v[40:43], v[120:123]
    v_mfma_f32_16x16x32_bf16 v[124:127], a[4:7], v[40:43], v[124:127]
    ds_read_b128 v[36:39], v201 offset:27648
    s_waitcnt lgkmcnt(2)
    v_mfma_f32_16x16x32_bf16 v[120:123], a[60:63], v[44:47], v[120:123]
    v_mfma_f32_16x16x32_bf16 v[124:127], a[64:67], v[44:47], v[124:127]
    ds_read_b128 v[40:43], v202 offset:20736
    s_waitcnt lgkmcnt(2)
    v_mfma_f32_16x16x32_bf16 v[120:123], a[48:51], v[32:35], v[120:123]
    v_cvt_pk_bf16_f32 v24, v108, v109
    v_cvt_pk_bf16_f32 v25, v110, v111
    v_mfma_f32_16x16x32_bf16 v[124:127], a[52:55], v[32:35], v[124:127]
    v_cvt_pk_bf16_f32 v26, v112, v113
    v_cvt_pk_bf16_f32 v27, v114, v115
    ds_read_b128 v[44:47], v202 offset:24192
    s_waitcnt lgkmcnt(2)
    v_mfma_f32_16x16x32_bf16 v[120:123], a[36:39], v[36:39], v[120:123]
    s_add_u32 s38, s35, 215040
    v_permlane16_swap_b32 v24, v26
    v_mfma_f32_16x16x32_bf16 v[124:127], a[40:43], v[36:39], v[124:127]
    v_permlane16_swap_b32 v25, v27
    ds_read_b128 v[32:35], v202 offset:27648
    s_waitcnt lgkmcnt(2)
    v_mfma_f32_16x16x32_bf16 v[120:123], a[96:99], v[40:43], v[120:123]
    buffer_store_dwordx4 v[24:27], v14, s[12:15], s38 offen nt
    v_mfma_f32_16x16x32_bf16 v[124:127], a[100:103], v[40:43], v[124:127]
    ds_read_b128 v[36:39], v203 offset:20736
    s_waitcnt lgkmcnt(2)
    v_mfma_f32_16x16x32_bf16 v[120:123], a[84:87], v[44:47], v[120:123]
    v_mfma_f32_16x16x32_bf16 v[124:127], a[88:91], v[44:47], v[124:127]
    ds_read_b128 v[40:43], v203 offset:24192
    s_waitcnt lgkmcnt(2)
    v_mfma_f32_16x16x32_bf16 v[120:123], a[72:75], v[32:35], v[120:123]
    v_mfma_f32_16x16x32_bf16 v[124:127], a[76:79], v[32:35], v[124:127]
    ds_read_b128 v[44:47], v203 offset:27648
    s_waitcnt lgkmcnt(2)
    v_mfma_f32_16x16x32_bf16 v[120:123], a[132:135], v[36:39], v[120:123]
    v_mfma_f32_16x16x32_bf16 v[124:127], a[136:139], v[36:39], v[124:127]
    ds_read_b128 v[32:35], v204 offset:20736
    s_waitcnt lgkmcnt(2)
    v_mfma_f32_16x16x32_bf16 v[120:123], a[120:123], v[40:43], v[120:123]
    v_mfma_f32_16x16x32_bf16 v[124:127], a[124:127], v[40:43], v[124:127]
    ds_read_b128 v[36:39], v204 offset:24192
    s_waitcnt lgkmcnt(2)
    v_mfma_f32_16x16x32_bf16 v[120:123], a[108:111], v[44:47], v[120:123]
    v_mfma_f32_16x16x32_bf16 v[124:127], a[112:115], v[44:47], v[124:127]
    ds_read_b128 v[40:43], v204 offset:27648
    s_waitcnt lgkmcnt(2)
    v_mfma_f32_16x16x32_bf16 v[120:123], a[168:171], v[32:35], v[120:123]
    v_mfma_f32_16x16x32_bf16 v[124:127], a[172:175], v[32:35], v[124:127]
    ds_read_b128 v[44:47], v205 offset:20736
    s_waitcnt lgkmcnt(2)
    v_mfma_f32_16x16x32_bf16 v[120:123], a[156:159], v[36:39], v[120:123]
    v_mfma_f32_16x16x32_bf16 v[124:127], a[160:163], v[36:39], v[124:127]
    ds_read_b128 v[32:35], v205 offset:24192
    s_waitcnt lgkmcnt(2)
    v_mfma_f32_16x16x32_bf16 v[120:123], a[144:147], v[40:43], v[120:123]
    v_mfma_f32_16x16x32_bf16 v[124:127], a[148:151], v[40:43], v[124:127]
    ds_read_b128 v[36:39], v205 offset:27648
    s_waitcnt lgkmcnt(2)
    v_mfma_f32_16x16x32_bf16 v[120:123], a[204:207], v[44:47], v[120:123]
    v_mfma_f32_16x16x32_bf16 v[124:127], a[208:211], v[44:47], v[124:127]
    ds_read_b128 v[40:43], v206 offset:20736
    s_waitcnt lgkmcnt(2)
    v_mfma_f32_16x16x32_bf16 v[120:123], a[192:195], v[32:35], v[120:123]
    v_mfma_f32_16x16x32_bf16 v[124:127], a[196:199], v[32:35], v[124:127]
    ds_read_b128 v[44:47], v206 offset:24192
    s_waitcnt lgkmcnt(2)
    v_mfma_f32_16x16x32_bf16 v[120:123], a[180:183], v[36:39], v[120:123]
    v_mfma_f32_16x16x32_bf16 v[124:127], a[184:187], v[36:39], v[124:127]
    ds_read_b128 v[32:35], v206 offset:27648
    s_waitcnt lgkmcnt(2)
    v_mfma_f32_16x16x32_bf16 v[120:123], a[240:243], v[40:43], v[120:123]
    v_mfma_f32_16x16x32_bf16 v[124:127], a[244:247], v[40:43], v[124:127]
    ds_read_b128 v[36:39], v207 offset:20736
    s_waitcnt lgkmcnt(2)
    v_mfma_f32_16x16x32_bf16 v[120:123], a[228:231], v[44:47], v[120:123]
    v_mfma_f32_16x16x32_bf16 v[124:127], a[232:235], v[44:47], v[124:127]
    ds_read_b128 v[40:43], v207 offset:24192
    s_waitcnt lgkmcnt(2)
    v_mfma_f32_16x16x32_bf16 v[120:123], a[216:219], v[32:35], v[120:123]
    v_mfma_f32_16x16x32_bf16 v[124:127], a[220:223], v[32:35], v[124:127]
    ds_read_b128 v[44:47], v207 offset:27648
    s_waitcnt lgkmcnt(2)
    v_mfma_f32_16x16x32_bf16 v[120:123], v[152:155], v[36:39], v[120:123]
    v_mfma_f32_16x16x32_bf16 v[124:127], v[156:159], v[36:39], v[124:127]
    ds_read_b128 v[32:35], v208 offset:20736
    s_waitcnt lgkmcnt(2)
    v_mfma_f32_16x16x32_bf16 v[120:123], v[140:143], v[40:43], v[120:123]
    v_mfma_f32_16x16x32_bf16 v[124:127], v[144:147], v[40:43], v[124:127]
    ds_read_b128 v[36:39], v208 offset:24192
    s_waitcnt lgkmcnt(2)
    v_mfma_f32_16x16x32_bf16 v[120:123], a[252:255], v[44:47], v[120:123]
    v_mfma_f32_16x16x32_bf16 v[124:127], v[132:135], v[44:47], v[124:127]
    ds_read_b128 v[40:43], v208 offset:27648
    s_waitcnt lgkmcnt(2)
    v_mfma_f32_16x16x32_bf16 v[120:123], v[188:191], v[32:35], v[120:123]
    v_mfma_f32_16x16x32_bf16 v[124:127], v[192:195], v[32:35], v[124:127]
    s_waitcnt lgkmcnt(1)
    v_mfma_f32_16x16x32_bf16 v[120:123], v[176:179], v[36:39], v[120:123]
    v_mfma_f32_16x16x32_bf16 v[124:127], v[180:183], v[36:39], v[124:127]
    s_waitcnt lgkmcnt(0)
    v_mfma_f32_16x16x32_bf16 v[120:123], v[164:167], v[40:43], v[120:123]
    v_mfma_f32_16x16x32_bf16 v[124:127], v[168:171], v[40:43], v[124:127]
    s_nop 7
    v_cvt_pk_bf16_f32 v16, v120, v121
    v_cvt_pk_bf16_f32 v17, v122, v123
    v_cvt_pk_bf16_f32 v18, v124, v125
    v_cvt_pk_bf16_f32 v19, v126, v127
    s_nop 1
    s_add_u32 s38, s35, 258048
    v_permlane16_swap_b32 v16, v18
    v_permlane16_swap_b32 v17, v19
    buffer_store_dwordx4 v[16:19], v14, s[12:15], s38 offen nt
L_fin:
L_end:
    s_endpgm
.section .rodata,"a"
.p2align 6
.amdhsa_kernel standalone__fft_conv__vision_kernel
  .amdhsa_next_free_vgpr 512
  .amdhsa_next_free_sgpr 102
  .amdhsa_accum_offset 256
  .amdhsa_group_segment_fixed_size 0
  .amdhsa_kernarg_size 40
  .amdhsa_user_sgpr_count 2
  .amdhsa_user_sgpr_kernarg_segment_ptr 1
  .amdhsa_system_sgpr_workgroup_id_x 1
.end_amdhsa_kernel
```
